```python
import torch

def _softmax(x, axis=-1):
    return torch.softmax(x, dim=axis)
def _gelu(x):
    return torch.nn.functional.gelu(x, approximate="tanh")
def _silu(x):
    return torch.nn.functional.silu(x)
def _sigmoid(x):
    return torch.sigmoid(x)
def _layernorm(x, axis=-1, eps=1e-5):
    m = x.mean(dim=axis, keepdim=True)
    v = x.var(dim=axis, keepdim=True, unbiased=False)
    return (x - m) / torch.sqrt(v + eps)
def _scatter_add(tgt, idx, src, axis=0):
    return tgt.clone().index_add_(axis, idx, src)
def _segment_sum(src, seg, n):
    out = torch.zeros((n,) + src.shape[1:], dtype=src.dtype)
    return out.index_add_(0, seg, src)
def _pad(x, pw):
    flat = tuple(v for pair in reversed(pw) for v in pair)
    return torch.nn.functional.pad(x, flat)

kernel_name = 'concat_heads__gqa_block_cached__gqa_block_cached__near_ridge'

def setup_inputs():

    _w = (lambda a: (lambda t: t.to(torch.bfloat16) if t.is_floating_point() else t)(torch.as_tensor(a)))
    def _A_setup():
        B, Sq, D = 32, 32, 448
        Hq, Hkv, Sk, Dh = 16, 8, 32, 256
        assert Hq % Hkv == 0, (Hq, Hkv)
        return {
            "x": _w((lambda *s: torch.randn(*s, dtype=torch.bfloat16) * 0.8)(B, Sq, D)),
            "k_cache": _w((lambda *s: torch.randn(*s, dtype=torch.bfloat16) * 0.8)(B, Hkv, Sk, Dh)),
            "v_cache": _w((lambda *s: torch.randn(*s, dtype=torch.bfloat16) * 0.05)(B, Hkv, Sk, Dh)),
            "wq": _w((lambda *s: torch.randn(*s, dtype=torch.bfloat16) * 0.8)(D, Hq * Dh) * (D ** -0.5)),
            "wo": _w((lambda *s: torch.randn(*s, dtype=torch.bfloat16) * 0.05)(Hq * Dh, D) * ((Hq * Dh) ** -0.5)),
        }
    _A_in = _A_setup()

    def _B_setup():
        B, Sq, D = 32, 32, 448
        Hq, Hkv, Sk, Dh = 16, 8, 32, 256
        assert Hq % Hkv == 0, (Hq, Hkv)
        return {
            "x": _w((lambda *s: torch.randn(*s, dtype=torch.bfloat16) * 0.8)(B, Sq, D)),
            "k_cache": _w((lambda *s: torch.randn(*s, dtype=torch.bfloat16) * 0.8)(B, Hkv, Sk, Dh)),
            "v_cache": _w((lambda *s: torch.randn(*s, dtype=torch.bfloat16) * 0.05)(B, Hkv, Sk, Dh)),
            "wq": _w((lambda *s: torch.randn(*s, dtype=torch.bfloat16) * 0.8)(D, Hq * Dh) * (D ** -0.5)),
            "wo": _w((lambda *s: torch.randn(*s, dtype=torch.bfloat16) * 0.05)(Hq * Dh, D) * ((Hq * Dh) ** -0.5)),
        }
    _B_in = _B_setup()

    return {
        "A_x": _A_in["x"],
        "A_k_cache": _A_in["k_cache"],
        "A_v_cache": _A_in["v_cache"],
        "A_wq": _A_in["wq"],
        "A_wo": _A_in["wo"],
        "B_x": _B_in["x"],
        "B_k_cache": _B_in["k_cache"],
        "B_v_cache": _B_in["v_cache"],
        "B_wq": _B_in["wq"],
        "B_wo": _B_in["wo"],
    }

def reference(A_x, A_k_cache, A_v_cache, A_wq, A_wo, B_x, B_k_cache, B_v_cache, B_wq, B_wo):
    def _A_ref(x, k_cache, v_cache, wq, wo):
        B, Sq, D = x.shape
        Hq, Dh = 16, 256
        Hkv = k_cache.shape[1]
        rep = Hq // Hkv
        q = (lambda x, *d: x.permute(*d))((x @ wq).reshape(B, Sq, Hq, Dh), 0, 2, 1, 3)
        k = (lambda x, n, axis: torch.repeat_interleave(x, n, dim=axis))(k_cache, rep, axis=1)
        v = (lambda x, n, axis: torch.repeat_interleave(x, n, dim=axis))(v_cache, rep, axis=1)
        scores = torch.einsum("bhqd,bhkd->bhqk", q, k) * (Dh ** -0.5)
        p = _softmax(scores, axis=-1)
        o = torch.einsum("bhqk,bhkd->bhqd", p, v)
        return (lambda x, *d: x.permute(*d))(o, 0, 2, 1, 3).reshape(B, Sq, Hq * Dh) @ wo

    def _B_ref(x, k_cache, v_cache, wq, wo):
        B, Sq, D = x.shape
        Hq, Dh = 16, 256
        Hkv = k_cache.shape[1]
        rep = Hq // Hkv
        q = (lambda x, *d: x.permute(*d))((x @ wq).reshape(B, Sq, Hq, Dh), 0, 2, 1, 3)
        k = (lambda x, n, axis: torch.repeat_interleave(x, n, dim=axis))(k_cache, rep, axis=1)
        v = (lambda x, n, axis: torch.repeat_interleave(x, n, dim=axis))(v_cache, rep, axis=1)
        scores = torch.einsum("bhqd,bhkd->bhqk", q, k) * (Dh ** -0.5)
        p = _softmax(scores, axis=-1)
        o = torch.einsum("bhqk,bhkd->bhqd", p, v)
        return (lambda x, *d: x.permute(*d))(o, 0, 2, 1, 3).reshape(B, Sq, Hq * Dh) @ wo

    a = _A_ref(A_x, A_k_cache, A_v_cache, A_wq, A_wo)
    b = _B_ref(B_x, B_k_cache, B_v_cache, B_wq, B_wo)
    return torch.concatenate([a, b], axis=-1)
```

```asm
; @launch grid=(256,1,1) block=(256,1,1) lds=163840
.amdgcn_target "amdgcn-amd-amdhsa--gfx950"
.text
.globl concat_heads__gqa_block_cached__gqa_block_cached__near_ridge_kernel
.p2align 8
.type concat_heads__gqa_block_cached__gqa_block_cached__near_ridge_kernel,@function
concat_heads__gqa_block_cached__gqa_block_cached__near_ridge_kernel:
    s_cmp_ge_u32 s2, 256
    s_cbranch_scc1 L_exit
    s_load_dwordx16 s[76:91], s[0:1], 0
    s_load_dwordx4 s[92:95], s[0:1], 64
    s_load_dwordx4 s[96:99], s[0:1], 80
    s_load_dwordx2 s[100:101], s[0:1], 96
    v_lshrrev_b32 v1, 6, v0
    v_and_b32 v0, 63, v0
    v_readfirstlane_b32 s34, v1
    s_and_b32 s60, s2, 7
    s_lshr_b32 s61, s2, 3
    s_lshr_b32 s35, s60, 2
    s_and_b32 s62, s60, 3
    s_and_b32 s63, s61, 3
    s_lshl_b32 s36, s62, 2
    s_add_u32 s36, s36, s63
    s_lshr_b32 s37, s61, 2
    s_and_b32 s64, s36, 1
    s_lshl_b32 s64, s64, 1
    s_add_u32 s64, s64, s34
    s_and_b32 s40, s64, 3
    s_lshr_b32 s64, s62, 1
    s_and_b32 s65, s62, 1
    s_and_b32 s66, s61, 7
    s_lshr_b32 s67, s61, 3
    s_lshl_b32 s68, s65, 2
    s_add_u32 s67, s67, s68
    s_and_b32 s69, s61, 3
    s_add_u32 s69, s69, s68
    s_cmp_ge_u32 s61, 24
    s_cselect_b32 s66, s69, s66
    s_cselect_b32 s67, 3, s67
    s_cmp_ge_u32 s61, 28
    s_cselect_b32 s39, 7, s67
    s_lshl_b32 s68, s64, 3
    s_add_u32 s38, s68, s66
    s_add_u32 s68, s66, s67
    s_and_b32 s43, s68, 3
    s_xor_b32 s3, s64, s65
    v_lshrrev_b32 v1, 3, v0
    v_and_b32 v2, 7, v0
    v_bfe_u32 v3, v0, 4, 1
    v_lshlrev_b32 v3, 1, v3
    v_xor_b32 v3, v3, v2
    v_lshlrev_b32 v54, 4, v3
    v_xor_b32 v3, 4, v3
    v_lshlrev_b32 v55, 4, v3
    v_lshlrev_b32 v56, 13, v1
    v_mul_u32_u24 v57, 896, v1
    v_add_u32 v4, v54, v56
    v_add_u32 v16, v54, v57
    v_add_u32 v5, v55, v56
    v_add_u32 v5, 65536, v5
    v_add_u32 v17, v55, v57
    v_add_u32 v17, 7168, v17
    v_add_u32 v6, v54, v56
    v_add_u32 v6, 131072, v6
    v_add_u32 v18, v54, v57
    v_add_u32 v18, 14336, v18
    v_add_u32 v7, v55, v56
    v_add_u32 v7, 196608, v7
    v_add_u32 v19, v55, v57
    v_add_u32 v19, 21504, v19
    v_lshrrev_b32 v3, 4, v0
    v_xor_b32 v3, v3, v2
    v_lshlrev_b32 v54, 4, v3
    v_xor_b32 v3, 4, v3
    v_lshlrev_b32 v55, 4, v3
    v_mul_u32_u24 v56, 896, v1
    v_lshlrev_b32 v57, 9, v1
    v_add_u32 v8, v54, v56
    v_add_u32 v12, v54, v57
    v_add_u32 v9, v55, v56
    v_add_u32 v9, 7168, v9
    v_add_u32 v13, v55, v57
    v_add_u32 v13, 4096, v13
    v_add_u32 v10, v54, v56
    v_add_u32 v10, 14336, v10
    v_add_u32 v14, v54, v57
    v_add_u32 v14, 8192, v14
    v_add_u32 v11, v55, v56
    v_add_u32 v11, 21504, v11
    v_add_u32 v15, v55, v57
    v_add_u32 v15, 12288, v15
    s_mul_i32 s41, s34, 28672
    s_lshl_b32 s42, s34, 12
    s_add_u32 s42, s42, 114688
    s_lshl_b32 s64, s63, 1
    s_add_u32 s64, s64, s37
    s_cmp_ge_u32 s64, 7
    s_cselect_b32 s65, 7, 0
    s_sub_u32 s64, s64, s65
    s_lshl_b32 s65, s37, 2
    s_add_u32 s65, s65, s34
    s_mul_i32 s66, s65, 28672
    s_lshl_b32 s67, s36, 9
    s_lshl_b32 s68, s34, 7
    s_add_u32 s67, s67, s68
    s_lshl_b32 s69, s64, 7
    s_add_u32 s44, s66, s69
    s_lshl_b32 s69, s64, 19
    s_add_u32 s51, s67, s69
    s_add_u32 s64, s64, 1
    s_cmp_eq_u32 s64, 7
    s_cselect_b32 s64, 0, s64
    s_lshl_b32 s69, s64, 7
    s_add_u32 s45, s66, s69
    s_lshl_b32 s69, s64, 19
    s_add_u32 s52, s67, s69
    s_add_u32 s64, s64, 1
    s_cmp_eq_u32 s64, 7
    s_cselect_b32 s64, 0, s64
    s_lshl_b32 s69, s64, 7
    s_add_u32 s46, s66, s69
    s_lshl_b32 s69, s64, 19
    s_add_u32 s53, s67, s69
    s_add_u32 s64, s64, 1
    s_cmp_eq_u32 s64, 7
    s_cselect_b32 s64, 0, s64
    s_lshl_b32 s69, s64, 7
    s_add_u32 s47, s66, s69
    s_lshl_b32 s69, s64, 19
    s_add_u32 s54, s67, s69
    s_add_u32 s64, s64, 1
    s_cmp_eq_u32 s64, 7
    s_cselect_b32 s64, 0, s64
    s_lshl_b32 s69, s64, 7
    s_add_u32 s48, s66, s69
    s_lshl_b32 s69, s64, 19
    s_add_u32 s55, s67, s69
    s_add_u32 s64, s64, 1
    s_cmp_eq_u32 s64, 7
    s_cselect_b32 s64, 0, s64
    s_lshl_b32 s69, s64, 7
    s_add_u32 s49, s66, s69
    s_lshl_b32 s69, s64, 19
    s_add_u32 s56, s67, s69
    s_add_u32 s64, s64, 1
    s_cmp_eq_u32 s64, 7
    s_cselect_b32 s64, 0, s64
    s_lshl_b32 s69, s64, 7
    s_add_u32 s50, s66, s69
    s_lshl_b32 s69, s64, 19
    s_add_u32 s57, s67, s69
    s_waitcnt lgkmcnt(0)
    s_cmp_eq_u32 s35, 0
    s_cselect_b32 s4, s76, s86
    s_cselect_b32 s5, s77, s87
    s_mov_b32 s6, 917504
    s_mov_b32 s7, 0x20000
    s_cselect_b32 s8, s82, s92
    s_cselect_b32 s9, s83, s93
    s_mov_b32 s10, 3670016
    s_mov_b32 s11, 0x20000
    s_and_b32 s5, s5, 0xffff
    s_and_b32 s9, s9, 0xffff
    s_add_u32 m0, s42, 0
    s_nop 0
    buffer_load_dwordx4 v8, s[4:7], s44 offen lds
    s_addk_i32 m0, 0x400
    s_nop 0
    buffer_load_dwordx4 v9, s[4:7], s44 offen lds
    s_addk_i32 m0, 0x400
    s_nop 0
    buffer_load_dwordx4 v10, s[4:7], s44 offen lds
    s_addk_i32 m0, 0x400
    s_nop 0
    buffer_load_dwordx4 v11, s[4:7], s44 offen lds
    s_add_u32 m0, s41, 0
    s_mov_b32 s73, s51
    buffer_load_dwordx4 v4, s[8:11], s73 offen lds
    s_addk_i32 m0, 0x400
    s_nop 0
    buffer_load_dwordx4 v5, s[8:11], s73 offen lds
    s_addk_i32 m0, 0x400
    s_nop 0
    buffer_load_dwordx4 v6, s[8:11], s73 offen lds
    s_addk_i32 m0, 0x400
    s_nop 0
    buffer_load_dwordx4 v7, s[8:11], s73 offen lds
    s_addk_i32 m0, 0x400
    s_add_u32 s73, s51, 262144
    buffer_load_dwordx4 v4, s[8:11], s73 offen lds
    s_addk_i32 m0, 0x400
    s_nop 0
    buffer_load_dwordx4 v5, s[8:11], s73 offen lds
    s_addk_i32 m0, 0x400
    s_nop 0
    buffer_load_dwordx4 v6, s[8:11], s73 offen lds
    s_addk_i32 m0, 0x400
    s_nop 0
    buffer_load_dwordx4 v7, s[8:11], s73 offen lds
    s_add_u32 m0, s42, 16384
    s_nop 0
    buffer_load_dwordx4 v8, s[4:7], s45 offen lds
    s_addk_i32 m0, 0x400
    s_nop 0
    buffer_load_dwordx4 v9, s[4:7], s45 offen lds
    s_addk_i32 m0, 0x400
    s_nop 0
    buffer_load_dwordx4 v10, s[4:7], s45 offen lds
    s_addk_i32 m0, 0x400
    s_nop 0
    buffer_load_dwordx4 v11, s[4:7], s45 offen lds
    s_cmp_eq_u32 s35, 0
    s_cselect_b32 s12, s78, s88
    s_cselect_b32 s13, s79, s89
    s_mov_b32 s14, 4194304
    s_mov_b32 s15, 0x20000
    s_cselect_b32 s16, s80, s90
    s_cselect_b32 s17, s81, s91
    s_mov_b32 s18, 4194304
    s_mov_b32 s19, 0x20000
    s_cselect_b32 s20, s84, s94
    s_cselect_b32 s21, s85, s95
    s_mov_b32 s22, 3670016
    s_mov_b32 s23, 0x20000
    s_and_b32 s13, s13, 0xffff
    s_and_b32 s17, s17, 0xffff
    s_and_b32 s21, s21, 0xffff
    s_mov_b32 s28, s96
    s_and_b32 s29, s97, 0xffff
    s_mov_b32 s30, 1835008
    s_mov_b32 s31, 0x20000
    s_mov_b32 s24, s100
    s_and_b32 s25, s101, 0xffff
    s_mov_b32 s26, 2097152
    s_mov_b32 s27, 0x20000
    s_mov_b32 s32, s98
    s_mov_b32 s33, s99
    s_cmp_lt_u32 s39, 7
    s_cselect_b32 s18, s18, 0
    s_cselect_b32 s22, s22, 0
    s_lshl_b32 s62, s43, 7
    s_mul_i32 s66, s43, 57344
    s_add_u32 s43, s43, 1
    s_and_b32 s43, s43, 3
    s_lshl_b32 s63, s43, 7
    s_mul_i32 s67, s43, 57344
    s_add_u32 s43, s43, 1
    s_and_b32 s43, s43, 3
    s_lshl_b32 s64, s43, 7
    s_mul_i32 s68, s43, 57344
    s_add_u32 s43, s43, 1
    s_and_b32 s43, s43, 3
    s_lshl_b32 s65, s43, 7
    s_mul_i32 s69, s43, 57344
    s_lshl_b32 s43, s34, 1
    s_add_u32 s0, s43, s3
    s_xor_b32 s3, s3, 1
    s_add_u32 s1, s43, s3
    s_lshl_b32 s3, s38, 4
    s_add_u32 s43, s3, s0
    s_lshl_b32 s70, s43, 14
    s_add_u32 s71, s70, 131072
    s_mul_i32 s72, s0, 458752
    s_lshl_b32 s43, s39, 7
    s_add_u32 s72, s72, s43
    s_lshl_b32 s43, s35, 5
    s_lshl_b32 s74, s38, 1
    s_add_u32 s43, s43, s74
    s_lshl_b32 s43, s43, 4
    s_lshl_b32 s74, s0, 1
    s_add_u32 s43, s43, s74
    s_lshl_b32 s77, s43, 11
    s_add_u32 s78, s77, 32768
    s_add_u32 s43, s3, s1
    s_lshl_b32 s85, s43, 14
    s_add_u32 s86, s85, 131072
    s_mul_i32 s87, s1, 458752
    s_lshl_b32 s43, s39, 7
    s_add_u32 s87, s87, s43
    s_lshl_b32 s43, s35, 5
    s_lshl_b32 s74, s38, 1
    s_add_u32 s43, s43, s74
    s_lshl_b32 s43, s43, 4
    s_lshl_b32 s74, s1, 1
    s_add_u32 s43, s43, s74
    s_lshl_b32 s79, s43, 11
    s_add_u32 s80, s79, 32768
    s_lshr_b32 s0, s36, 1
    s_lshl_b32 s1, s37, 5
    s_add_u32 s0, s0, s1
    s_lshl_b32 s0, s0, 14
    s_lshl_b32 s1, s34, 7
    s_add_u32 s0, s0, s1
    s_add_u32 s1, s40, 0
    s_and_b32 s1, s1, 3
    s_lshl_b32 s1, s1, 17
    s_add_u32 s58, s0, s1
    s_add_u32 s1, s40, 1
    s_and_b32 s1, s1, 3
    s_lshl_b32 s1, s1, 17
    s_add_u32 s59, s0, s1
    s_add_u32 s1, s40, 2
    s_and_b32 s1, s1, 3
    s_lshl_b32 s1, s1, 17
    s_add_u32 s60, s0, s1
    s_add_u32 s1, s40, 3
    s_and_b32 s1, s1, 3
    s_lshl_b32 s1, s1, 17
    s_add_u32 s61, s0, s1
    v_lshrrev_b32 v1, 4, v0
    v_bfe_u32 v3, v0, 2, 2
    v_and_b32 v54, 3, v0
    v_lshrrev_b32 v55, 1, v3
    v_and_b32 v56, 1, v1
    v_lshlrev_b32 v56, 1, v56
    v_or_b32 v55, v55, v56
    v_lshlrev_b32 v2, 10, v1
    v_lshlrev_b32 v3, 7, v3
    v_add_u32 v2, v2, v3
    v_lshlrev_b32 v54, 3, v54
    v_add_u32 v2, v2, v54
    v_xor_b32 v54, 0, v55
    v_lshlrev_b32 v54, 5, v54
    v_add_u32 v54, v54, v2
    v_add_u32 v20, s41, v54
    v_add_u32 v24, s42, v54
    v_xor_b32 v54, 1, v55
    v_lshlrev_b32 v54, 5, v54
    v_add_u32 v54, v54, v2
    v_add_u32 v21, s41, v54
    v_add_u32 v25, s42, v54
    v_xor_b32 v54, 2, v55
    v_lshlrev_b32 v54, 5, v54
    v_add_u32 v54, v54, v2
    v_add_u32 v22, s41, v54
    v_add_u32 v26, s42, v54
    v_xor_b32 v54, 3, v55
    v_lshlrev_b32 v54, 5, v54
    v_add_u32 v54, v54, v2
    v_add_u32 v23, s41, v54
    v_add_u32 v27, s42, v54
    v_and_b32 v2, 15, v0
    v_lshrrev_b32 v55, 1, v2
    v_lshlrev_b32 v56, 7, v2
    v_xor_b32 v3, v55, v1
    v_lshlrev_b32 v3, 4, v3
    v_add_u32 v3, v3, v56
    s_add_u32 s0, s40, 0
    s_and_b32 s0, s0, 3
    s_lshl_b32 s0, s0, 12
    s_add_u32 s74, s0, 114688
    s_add_u32 s0, s40, 1
    s_and_b32 s0, s0, 3
    s_lshl_b32 s0, s0, 12
    s_add_u32 s75, s0, 114688
    s_add_u32 s0, s40, 2
    s_and_b32 s0, s0, 3
    s_lshl_b32 s0, s0, 12
    s_add_u32 s1, s0, 114688
    s_add_u32 s0, s40, 3
    s_and_b32 s0, s0, 3
    s_lshl_b32 s0, s0, 12
    s_add_u32 s43, s0, 114688
    v_xor_b32 v54, 0, v3
    v_add_u32 v28, s41, v54
    v_add_u32 v30, s42, v54
    v_add_u32 v32, s74, v54
    v_add_u32 v34, s75, v54
    v_add_u32 v36, s1, v54
    v_add_u32 v38, s43, v54
    v_xor_b32 v54, 64, v3
    v_add_u32 v29, s41, v54
    v_add_u32 v31, s42, v54
    v_add_u32 v33, s74, v54
    v_add_u32 v35, s75, v54
    v_add_u32 v37, s1, v54
    v_add_u32 v39, s43, v54
    v_lshrrev_b32 v3, 1, v1
    v_xor_b32 v3, v3, v55
    v_lshlrev_b32 v3, 4, v3
    v_add_u32 v3, v3, v56
    v_and_b32 v54, 1, v1
    v_lshlrev_b32 v54, 3, v54
    v_add_u32 v3, v3, v54
    v_add_u32 v3, s41, v3
    v_xor_b32 v40, 0, v3
    v_xor_b32 v41, 32, v3
    v_xor_b32 v42, 64, v3
    v_xor_b32 v43, 96, v3
    v_mul_u32_u24 v49, 1792, v2
    v_and_b32 v54, 1, v1
    v_lshlrev_b32 v54, 5, v54
    v_add_u32 v49, v49, v54
    v_lshrrev_b32 v54, 1, v1
    v_lshlrev_b32 v54, 4, v54
    v_add_u32 v49, v49, v54
    v_lshlrev_b32 v44, 4, v0
    s_add_u32 s0, s34, 1
    s_and_b32 s0, s0, 3
    s_mul_i32 s0, s0, 28672
    s_add_u32 s0, s0, 8192
    v_add_u32 v45, s0, v44
    s_add_u32 s0, s34, 2
    s_and_b32 s0, s0, 3
    s_mul_i32 s0, s0, 28672
    s_add_u32 s0, s0, 12288
    v_add_u32 v46, s0, v44
    s_add_u32 s0, s34, 3
    s_and_b32 s0, s0, 3
    s_lshl_b32 s0, s0, 12
    s_add_u32 s0, s0, 114688
    v_add_u32 v47, s0, v44
    v_add_u32 v48, s42, v44
    v_add_u32 v50, s41, v44
    s_lshl_b32 s0, s34, 12
    v_add_u32 v51, s0, v44
    v_add_u32 v52, 57344, v51
    s_lshl_b32 s0, s35, 5
    s_lshl_b32 s1, s37, 2
    s_add_u32 s0, s0, s1
    s_add_u32 s0, s0, s40
    s_lshl_b32 s0, s0, 4
    s_add_u32 s0, s0, s36
    s_lshl_b32 s76, s0, 11
    s_lshl_b32 s0, s38, 1
    s_lshr_b32 s1, s34, 1
    s_add_u32 s0, s0, s1
    s_mul_i32 s0, s0, 57344
    s_mul_i32 s1, s35, 896
    s_add_u32 s0, s0, s1
    s_lshl_b32 s1, s39, 7
    s_add_u32 s0, s0, s1
    s_and_b32 s1, s34, 1
    s_mul_i32 s1, s1, 28672
    s_add_u32 s81, s0, s1
    s_lshl_b32 s0, s35, 3
    s_add_u32 s1, s0, s37
    s_lshl_b32 s1, s1, 2
    s_lshr_b32 s3, s36, 2
    s_add_u32 s1, s1, s3
    s_lshl_b32 s82, s1, 2
    s_lshr_b32 s1, s38, 1
    s_add_u32 s1, s0, s1
    s_lshl_b32 s1, s1, 2
    s_add_u32 s1, s1, s34
    s_lshl_b32 s83, s1, 2
    s_lshl_b32 s0, s35, 3
    s_lshr_b32 s1, s38, 1
    s_add_u32 s0, s0, s1
    s_lshl_b32 s83, s0, 4
    s_mov_b32 s96, s32
    s_and_b32 s97, s33, 0xffff
    s_cmp_eq_u32 s34, 0
    s_cselect_b32 s98, 256, 0
    s_mov_b32 s99, 0x20000
    s_mov_b32 s84, 0x3db8aa3b
    s_waitcnt vmcnt(8)
    s_barrier
    ds_read_b64_tr_b16 a[0:1], v20 offset:0
    ds_read_b64_tr_b16 a[2:3], v20 offset:512
    ds_read_b128 a[32:35], v32 offset:0
    ds_read_b128 a[36:39], v32 offset:2048
    ds_read_b64_tr_b16 a[4:5], v21 offset:0
    ds_read_b64_tr_b16 a[6:7], v21 offset:512
    ds_read_b128 a[40:43], v34 offset:0
    ds_read_b128 a[44:47], v34 offset:2048
    ds_read_b64_tr_b16 a[8:9], v22 offset:0
    ds_read_b64_tr_b16 a[10:11], v22 offset:512
    ds_read_b128 a[48:51], v36 offset:0
    ds_read_b128 a[52:55], v36 offset:2048
    ds_read_b64_tr_b16 a[12:13], v23 offset:0
    ds_read_b64_tr_b16 a[14:15], v23 offset:512
    ds_read_b128 a[56:59], v38 offset:0
    ds_read_b128 a[60:63], v38 offset:2048
    s_waitcnt lgkmcnt(0)
    v_mfma_f32_16x16x32_bf16 v[128:131], a[0:3], a[32:35], 0
    s_waitcnt vmcnt(4)
    s_add_u32 m0, s41, 8192
    v_mfma_f32_16x16x32_bf16 v[132:135], a[0:3], a[36:39], 0
    ds_read_b64_tr_b16 a[16:17], v20 offset:4096
    s_mov_b32 s73, s52
    v_mfma_f32_16x16x32_bf16 v[136:139], a[0:3], a[40:43], 0
    ds_read_b64_tr_b16 a[18:19], v20 offset:4608
    buffer_load_dwordx4 v4, s[8:11], s73 offen lds
    v_mfma_f32_16x16x32_bf16 v[140:143], a[0:3], a[44:47], 0
    ds_read_b128 a[64:67], v33 offset:0
    s_addk_i32 m0, 0x400
    v_mfma_f32_16x16x32_bf16 v[144:147], a[0:3], a[48:51], 0
    buffer_load_dwordx4 v5, s[8:11], s73 offen lds
    v_mfma_f32_16x16x32_bf16 v[148:151], a[0:3], a[52:55], 0
    ds_read_b128 a[68:71], v33 offset:2048
    v_mfma_f32_16x16x32_bf16 v[152:155], a[0:3], a[56:59], 0
    ds_read_b64_tr_b16 a[20:21], v21 offset:4096
    s_addk_i32 m0, 0x400
    v_mfma_f32_16x16x32_bf16 v[156:159], a[0:3], a[60:63], 0
    ds_read_b64_tr_b16 a[22:23], v21 offset:4608
    buffer_load_dwordx4 v6, s[8:11], s73 offen lds
    v_mfma_f32_16x16x32_bf16 v[160:163], a[4:7], a[32:35], 0
    s_addk_i32 m0, 0x400
    v_mfma_f32_16x16x32_bf16 v[164:167], a[4:7], a[36:39], 0
    ds_read_b128 a[72:75], v35 offset:0
    buffer_load_dwordx4 v7, s[8:11], s73 offen lds
    v_mfma_f32_16x16x32_bf16 v[168:171], a[4:7], a[40:43], 0
    ds_read_b128 a[76:79], v35 offset:2048
    v_mfma_f32_16x16x32_bf16 v[172:175], a[4:7], a[44:47], 0
    ds_read_b64_tr_b16 a[24:25], v22 offset:4096
    s_addk_i32 m0, 0x400
    v_mfma_f32_16x16x32_bf16 v[176:179], a[4:7], a[48:51], 0
    ds_read_b64_tr_b16 a[26:27], v22 offset:4608
    s_add_u32 s73, s52, 262144
    v_mfma_f32_16x16x32_bf16 v[180:183], a[4:7], a[52:55], 0
    buffer_load_dwordx4 v4, s[8:11], s73 offen lds
    v_mfma_f32_16x16x32_bf16 v[184:187], a[4:7], a[56:59], 0
    ds_read_b128 a[80:83], v37 offset:0
    s_addk_i32 m0, 0x400
    v_mfma_f32_16x16x32_bf16 v[188:191], a[4:7], a[60:63], 0
    ds_read_b128 a[84:87], v37 offset:2048
    buffer_load_dwordx4 v5, s[8:11], s73 offen lds
    v_mfma_f32_16x16x32_bf16 v[192:195], a[8:11], a[32:35], 0
    ds_read_b64_tr_b16 a[28:29], v23 offset:4096
    v_mfma_f32_16x16x32_bf16 v[196:199], a[8:11], a[36:39], 0
    s_addk_i32 m0, 0x400
    v_mfma_f32_16x16x32_bf16 v[200:203], a[8:11], a[40:43], 0
    ds_read_b64_tr_b16 a[30:31], v23 offset:4608
    buffer_load_dwordx4 v6, s[8:11], s73 offen lds
    v_mfma_f32_16x16x32_bf16 v[204:207], a[8:11], a[44:47], 0
    ds_read_b128 a[88:91], v39 offset:0
    s_addk_i32 m0, 0x400
    v_mfma_f32_16x16x32_bf16 v[208:211], a[8:11], a[48:51], 0
    ds_read_b128 a[92:95], v39 offset:2048
    buffer_load_dwordx4 v7, s[8:11], s73 offen lds
    v_mfma_f32_16x16x32_bf16 v[212:215], a[8:11], a[52:55], 0
    v_mfma_f32_16x16x32_bf16 v[216:219], a[8:11], a[56:59], 0
    v_mfma_f32_16x16x32_bf16 v[220:223], a[8:11], a[60:63], 0
    v_mfma_f32_16x16x32_bf16 v[224:227], a[12:15], a[32:35], 0
    v_mfma_f32_16x16x32_bf16 v[228:231], a[12:15], a[36:39], 0
    v_mfma_f32_16x16x32_bf16 v[232:235], a[12:15], a[40:43], 0
    v_mfma_f32_16x16x32_bf16 v[236:239], a[12:15], a[44:47], 0
    v_mfma_f32_16x16x32_bf16 v[240:243], a[12:15], a[48:51], 0
    v_mfma_f32_16x16x32_bf16 v[244:247], a[12:15], a[52:55], 0
    v_mfma_f32_16x16x32_bf16 v[248:251], a[12:15], a[56:59], 0
    v_mfma_f32_16x16x32_bf16 v[252:255], a[12:15], a[60:63], 0
    s_waitcnt lgkmcnt(0)
    v_mfma_f32_16x16x32_bf16 v[128:131], a[16:19], a[64:67], v[128:131]
    v_mfma_f32_16x16x32_bf16 v[132:135], a[16:19], a[68:71], v[132:135]
    v_mfma_f32_16x16x32_bf16 v[136:139], a[16:19], a[72:75], v[136:139]
    s_waitcnt vmcnt(8)
    s_waitcnt vmcnt(4)
    s_barrier
    s_add_u32 m0, s42, 32768
    v_mfma_f32_16x16x32_bf16 v[140:143], a[16:19], a[76:79], v[140:143]
    buffer_load_dwordx4 v8, s[4:7], s46 offen lds
    v_mfma_f32_16x16x32_bf16 v[144:147], a[16:19], a[80:83], v[144:147]
    s_addk_i32 m0, 0x400
    v_mfma_f32_16x16x32_bf16 v[148:151], a[16:19], a[84:87], v[148:151]
    ds_read_b64_tr_b16 a[0:1], v20 offset:8192
    buffer_load_dwordx4 v9, s[4:7], s46 offen lds
    v_mfma_f32_16x16x32_bf16 v[152:155], a[16:19], a[88:91], v[152:155]
    ds_read_b64_tr_b16 a[2:3], v20 offset:8704
    s_addk_i32 m0, 0x400
    v_mfma_f32_16x16x32_bf16 v[156:159], a[16:19], a[92:95], v[156:159]
    ds_read_b128 a[32:35], v32 offset:16384
    v_mfma_f32_16x16x32_bf16 v[160:163], a[20:23], a[64:67], v[160:163]
    ds_read_b128 a[36:39], v32 offset:18432
    buffer_load_dwordx4 v10, s[4:7], s46 offen lds
    v_mfma_f32_16x16x32_bf16 v[164:167], a[20:23], a[68:71], v[164:167]
    ds_read_b64_tr_b16 a[4:5], v21 offset:8192
    s_addk_i32 m0, 0x400
    v_mfma_f32_16x16x32_bf16 v[168:171], a[20:23], a[72:75], v[168:171]
    ds_read_b64_tr_b16 a[6:7], v21 offset:8704
    buffer_load_dwordx4 v11, s[4:7], s46 offen lds
    v_mfma_f32_16x16x32_bf16 v[172:175], a[20:23], a[76:79], v[172:175]
    ds_read_b128 a[40:43], v34 offset:16384
    s_add_u32 m0, s41, 16384
    v_mfma_f32_16x16x32_bf16 v[176:179], a[20:23], a[80:83], v[176:179]
    v_mfma_f32_16x16x32_bf16 v[180:183], a[20:23], a[84:87], v[180:183]
    ds_read_b128 a[44:47], v34 offset:18432
    s_mov_b32 s73, s53
    v_mfma_f32_16x16x32_bf16 v[184:187], a[20:23], a[88:91], v[184:187]
    ds_read_b64_tr_b16 a[8:9], v22 offset:8192
    buffer_load_dwordx4 v4, s[8:11], s73 offen lds
    v_mfma_f32_16x16x32_bf16 v[188:191], a[20:23], a[92:95], v[188:191]
    ds_read_b64_tr_b16 a[10:11], v22 offset:8704
    s_addk_i32 m0, 0x400
    v_mfma_f32_16x16x32_bf16 v[192:195], a[24:27], a[64:67], v[192:195]
    ds_read_b128 a[48:51], v36 offset:16384
    buffer_load_dwordx4 v5, s[8:11], s73 offen lds
    v_mfma_f32_16x16x32_bf16 v[196:199], a[24:27], a[68:71], v[196:199]
    ds_read_b128 a[52:55], v36 offset:18432
    v_mfma_f32_16x16x32_bf16 v[200:203], a[24:27], a[72:75], v[200:203]
    ds_read_b64_tr_b16 a[12:13], v23 offset:8192
    s_addk_i32 m0, 0x400
    v_mfma_f32_16x16x32_bf16 v[204:207], a[24:27], a[76:79], v[204:207]
    ds_read_b64_tr_b16 a[14:15], v23 offset:8704
    buffer_load_dwordx4 v6, s[8:11], s73 offen lds
    v_mfma_f32_16x16x32_bf16 v[208:211], a[24:27], a[80:83], v[208:211]
    ds_read_b128 a[56:59], v38 offset:16384
    s_addk_i32 m0, 0x400
    v_mfma_f32_16x16x32_bf16 v[212:215], a[24:27], a[84:87], v[212:215]
    ds_read_b128 a[60:63], v38 offset:18432
    buffer_load_dwordx4 v7, s[8:11], s73 offen lds
    v_mfma_f32_16x16x32_bf16 v[216:219], a[24:27], a[88:91], v[216:219]
    v_mfma_f32_16x16x32_bf16 v[220:223], a[24:27], a[92:95], v[220:223]
    v_mfma_f32_16x16x32_bf16 v[224:227], a[28:31], a[64:67], v[224:227]
    v_mfma_f32_16x16x32_bf16 v[228:231], a[28:31], a[68:71], v[228:231]
    v_mfma_f32_16x16x32_bf16 v[232:235], a[28:31], a[72:75], v[232:235]
    v_mfma_f32_16x16x32_bf16 v[236:239], a[28:31], a[76:79], v[236:239]
    v_mfma_f32_16x16x32_bf16 v[240:243], a[28:31], a[80:83], v[240:243]
    v_mfma_f32_16x16x32_bf16 v[244:247], a[28:31], a[84:87], v[244:247]
    v_mfma_f32_16x16x32_bf16 v[248:251], a[28:31], a[88:91], v[248:251]
    v_mfma_f32_16x16x32_bf16 v[252:255], a[28:31], a[92:95], v[252:255]
    s_waitcnt lgkmcnt(0)
    v_mfma_f32_16x16x32_bf16 v[128:131], a[0:3], a[32:35], v[128:131]
    s_waitcnt vmcnt(8)
    s_add_u32 m0, s41, 0
    v_mfma_f32_16x16x32_bf16 v[132:135], a[0:3], a[36:39], v[132:135]
    ds_read_b64_tr_b16 a[16:17], v20 offset:12288
    s_add_u32 s73, s53, 262144
    v_mfma_f32_16x16x32_bf16 v[136:139], a[0:3], a[40:43], v[136:139]
    ds_read_b64_tr_b16 a[18:19], v20 offset:12800
    buffer_load_dwordx4 v4, s[8:11], s73 offen lds
    v_mfma_f32_16x16x32_bf16 v[140:143], a[0:3], a[44:47], v[140:143]
    ds_read_b128 a[64:67], v33 offset:16384
    s_addk_i32 m0, 0x400
    v_mfma_f32_16x16x32_bf16 v[144:147], a[0:3], a[48:51], v[144:147]
    v_mfma_f32_16x16x32_bf16 v[148:151], a[0:3], a[52:55], v[148:151]
    ds_read_b128 a[68:71], v33 offset:18432
    buffer_load_dwordx4 v5, s[8:11], s73 offen lds
    v_mfma_f32_16x16x32_bf16 v[152:155], a[0:3], a[56:59], v[152:155]
    ds_read_b64_tr_b16 a[20:21], v21 offset:12288
    s_addk_i32 m0, 0x400
    v_mfma_f32_16x16x32_bf16 v[156:159], a[0:3], a[60:63], v[156:159]
    ds_read_b64_tr_b16 a[22:23], v21 offset:12800
    buffer_load_dwordx4 v6, s[8:11], s73 offen lds
    v_mfma_f32_16x16x32_bf16 v[160:163], a[4:7], a[32:35], v[160:163]
    v_mfma_f32_16x16x32_bf16 v[164:167], a[4:7], a[36:39], v[164:167]
    ds_read_b128 a[72:75], v35 offset:16384
    s_addk_i32 m0, 0x400
    v_mfma_f32_16x16x32_bf16 v[168:171], a[4:7], a[40:43], v[168:171]
    ds_read_b128 a[76:79], v35 offset:18432
    buffer_load_dwordx4 v7, s[8:11], s73 offen lds
    v_mfma_f32_16x16x32_bf16 v[172:175], a[4:7], a[44:47], v[172:175]
    ds_read_b64_tr_b16 a[24:25], v22 offset:12288
    s_add_u32 m0, s42, 0
    v_mfma_f32_16x16x32_bf16 v[176:179], a[4:7], a[48:51], v[176:179]
    ds_read_b64_tr_b16 a[26:27], v22 offset:12800
    buffer_load_dwordx4 v8, s[4:7], s47 offen lds
    v_mfma_f32_16x16x32_bf16 v[180:183], a[4:7], a[52:55], v[180:183]
    v_mfma_f32_16x16x32_bf16 v[184:187], a[4:7], a[56:59], v[184:187]
    ds_read_b128 a[80:83], v37 offset:16384
    s_addk_i32 m0, 0x400
    v_mfma_f32_16x16x32_bf16 v[188:191], a[4:7], a[60:63], v[188:191]
    ds_read_b128 a[84:87], v37 offset:18432
    buffer_load_dwordx4 v9, s[4:7], s47 offen lds
    v_mfma_f32_16x16x32_bf16 v[192:195], a[8:11], a[32:35], v[192:195]
    ds_read_b64_tr_b16 a[28:29], v23 offset:12288
    s_addk_i32 m0, 0x400
    v_mfma_f32_16x16x32_bf16 v[196:199], a[8:11], a[36:39], v[196:199]
    v_mfma_f32_16x16x32_bf16 v[200:203], a[8:11], a[40:43], v[200:203]
    ds_read_b64_tr_b16 a[30:31], v23 offset:12800
    buffer_load_dwordx4 v10, s[4:7], s47 offen lds
    v_mfma_f32_16x16x32_bf16 v[204:207], a[8:11], a[44:47], v[204:207]
    ds_read_b128 a[88:91], v39 offset:16384
    s_addk_i32 m0, 0x400
    v_mfma_f32_16x16x32_bf16 v[208:211], a[8:11], a[48:51], v[208:211]
    ds_read_b128 a[92:95], v39 offset:18432
    buffer_load_dwordx4 v11, s[4:7], s47 offen lds
    v_mfma_f32_16x16x32_bf16 v[212:215], a[8:11], a[52:55], v[212:215]
    v_mfma_f32_16x16x32_bf16 v[216:219], a[8:11], a[56:59], v[216:219]
    v_mfma_f32_16x16x32_bf16 v[220:223], a[8:11], a[60:63], v[220:223]
    v_mfma_f32_16x16x32_bf16 v[224:227], a[12:15], a[32:35], v[224:227]
    v_mfma_f32_16x16x32_bf16 v[228:231], a[12:15], a[36:39], v[228:231]
    v_mfma_f32_16x16x32_bf16 v[232:235], a[12:15], a[40:43], v[232:235]
    v_mfma_f32_16x16x32_bf16 v[236:239], a[12:15], a[44:47], v[236:239]
    v_mfma_f32_16x16x32_bf16 v[240:243], a[12:15], a[48:51], v[240:243]
    v_mfma_f32_16x16x32_bf16 v[244:247], a[12:15], a[52:55], v[244:247]
    v_mfma_f32_16x16x32_bf16 v[248:251], a[12:15], a[56:59], v[248:251]
    v_mfma_f32_16x16x32_bf16 v[252:255], a[12:15], a[60:63], v[252:255]
    s_waitcnt lgkmcnt(0)
    v_mfma_f32_16x16x32_bf16 v[128:131], a[16:19], a[64:67], v[128:131]
    v_mfma_f32_16x16x32_bf16 v[132:135], a[16:19], a[68:71], v[132:135]
    v_mfma_f32_16x16x32_bf16 v[136:139], a[16:19], a[72:75], v[136:139]
    s_waitcnt vmcnt(12)
    s_waitcnt vmcnt(8)
    s_barrier
    s_add_u32 m0, s41, 4096
    v_mfma_f32_16x16x32_bf16 v[140:143], a[16:19], a[76:79], v[140:143]
    s_mov_b32 s73, s54
    v_mfma_f32_16x16x32_bf16 v[144:147], a[16:19], a[80:83], v[144:147]
    buffer_load_dwordx4 v4, s[8:11], s73 offen lds
    v_mfma_f32_16x16x32_bf16 v[148:151], a[16:19], a[84:87], v[148:151]
    ds_read_b64_tr_b16 a[0:1], v20 offset:16384
    s_addk_i32 m0, 0x400
    v_mfma_f32_16x16x32_bf16 v[152:155], a[16:19], a[88:91], v[152:155]
    ds_read_b64_tr_b16 a[2:3], v20 offset:16896
    buffer_load_dwordx4 v5, s[8:11], s73 offen lds
    v_mfma_f32_16x16x32_bf16 v[156:159], a[16:19], a[92:95], v[156:159]
    ds_read_b128 a[32:35], v32 offset:32768
    v_mfma_f32_16x16x32_bf16 v[160:163], a[20:23], a[64:67], v[160:163]
    ds_read_b128 a[36:39], v32 offset:34816
    s_addk_i32 m0, 0x400
    v_mfma_f32_16x16x32_bf16 v[164:167], a[20:23], a[68:71], v[164:167]
    ds_read_b64_tr_b16 a[4:5], v21 offset:16384
    buffer_load_dwordx4 v6, s[8:11], s73 offen lds
    v_mfma_f32_16x16x32_bf16 v[168:171], a[20:23], a[72:75], v[168:171]
    ds_read_b64_tr_b16 a[6:7], v21 offset:16896
    s_addk_i32 m0, 0x400
    v_mfma_f32_16x16x32_bf16 v[172:175], a[20:23], a[76:79], v[172:175]
    ds_read_b128 a[40:43], v34 offset:32768
    buffer_load_dwordx4 v7, s[8:11], s73 offen lds
    v_mfma_f32_16x16x32_bf16 v[176:179], a[20:23], a[80:83], v[176:179]
    v_mfma_f32_16x16x32_bf16 v[180:183], a[20:23], a[84:87], v[180:183]
    ds_read_b128 a[44:47], v34 offset:34816
    s_add_u32 m0, s41, 20480
    v_mfma_f32_16x16x32_bf16 v[184:187], a[20:23], a[88:91], v[184:187]
    ds_read_b64_tr_b16 a[8:9], v22 offset:16384
    buffer_load_dwordx4 v12, s[12:15], s58 offen lds
    v_mfma_f32_16x16x32_bf16 v[188:191], a[20:23], a[92:95], v[188:191]
    ds_read_b64_tr_b16 a[10:11], v22 offset:16896
    s_addk_i32 m0, 0x400
    v_mfma_f32_16x16x32_bf16 v[192:195], a[24:27], a[64:67], v[192:195]
    ds_read_b128 a[48:51], v36 offset:32768
    buffer_load_dwordx4 v13, s[12:15], s58 offen lds
    v_mfma_f32_16x16x32_bf16 v[196:199], a[24:27], a[68:71], v[196:199]
    ds_read_b128 a[52:55], v36 offset:34816
    v_mfma_f32_16x16x32_bf16 v[200:203], a[24:27], a[72:75], v[200:203]
    ds_read_b64_tr_b16 a[12:13], v23 offset:16384
    s_addk_i32 m0, 0x400
    v_mfma_f32_16x16x32_bf16 v[204:207], a[24:27], a[76:79], v[204:207]
    ds_read_b64_tr_b16 a[14:15], v23 offset:16896
    buffer_load_dwordx4 v14, s[12:15], s58 offen lds
    v_mfma_f32_16x16x32_bf16 v[208:211], a[24:27], a[80:83], v[208:211]
    ds_read_b128 a[56:59], v38 offset:32768
    s_addk_i32 m0, 0x400
    v_mfma_f32_16x16x32_bf16 v[212:215], a[24:27], a[84:87], v[212:215]
    ds_read_b128 a[60:63], v38 offset:34816
    buffer_load_dwordx4 v15, s[12:15], s58 offen lds
    v_mfma_f32_16x16x32_bf16 v[216:219], a[24:27], a[88:91], v[216:219]
    v_mfma_f32_16x16x32_bf16 v[220:223], a[24:27], a[92:95], v[220:223]
    v_mfma_f32_16x16x32_bf16 v[224:227], a[28:31], a[64:67], v[224:227]
    v_mfma_f32_16x16x32_bf16 v[228:231], a[28:31], a[68:71], v[228:231]
    v_mfma_f32_16x16x32_bf16 v[232:235], a[28:31], a[72:75], v[232:235]
    v_mfma_f32_16x16x32_bf16 v[236:239], a[28:31], a[76:79], v[236:239]
    v_mfma_f32_16x16x32_bf16 v[240:243], a[28:31], a[80:83], v[240:243]
    v_mfma_f32_16x16x32_bf16 v[244:247], a[28:31], a[84:87], v[244:247]
    v_mfma_f32_16x16x32_bf16 v[248:251], a[28:31], a[88:91], v[248:251]
    v_mfma_f32_16x16x32_bf16 v[252:255], a[28:31], a[92:95], v[252:255]
    s_waitcnt lgkmcnt(0)
    v_mfma_f32_16x16x32_bf16 v[128:131], a[0:3], a[32:35], v[128:131]
    s_waitcnt vmcnt(12)
    s_addk_i32 m0, 0x400
    v_mfma_f32_16x16x32_bf16 v[132:135], a[0:3], a[36:39], v[132:135]
    ds_read_b64_tr_b16 a[16:17], v20 offset:0
    buffer_load_dwordx4 v12, s[12:15], s59 offen lds
    v_mfma_f32_16x16x32_bf16 v[136:139], a[0:3], a[40:43], v[136:139]
    ds_read_b64_tr_b16 a[18:19], v20 offset:512
    s_addk_i32 m0, 0x400
    v_mfma_f32_16x16x32_bf16 v[140:143], a[0:3], a[44:47], v[140:143]
    ds_read_b128 a[64:67], v33 offset:32768
    buffer_load_dwordx4 v13, s[12:15], s59 offen lds
    v_mfma_f32_16x16x32_bf16 v[144:147], a[0:3], a[48:51], v[144:147]
    s_addk_i32 m0, 0x400
    v_mfma_f32_16x16x32_bf16 v[148:151], a[0:3], a[52:55], v[148:151]
    ds_read_b128 a[68:71], v33 offset:34816
    buffer_load_dwordx4 v14, s[12:15], s59 offen lds
    v_mfma_f32_16x16x32_bf16 v[152:155], a[0:3], a[56:59], v[152:155]
    ds_read_b64_tr_b16 a[20:21], v21 offset:0
    s_addk_i32 m0, 0x400
    v_mfma_f32_16x16x32_bf16 v[156:159], a[0:3], a[60:63], v[156:159]
    ds_read_b64_tr_b16 a[22:23], v21 offset:512
    buffer_load_dwordx4 v15, s[12:15], s59 offen lds
    v_mfma_f32_16x16x32_bf16 v[160:163], a[4:7], a[32:35], v[160:163]
    s_add_u32 m0, s41, 8192
    v_mfma_f32_16x16x32_bf16 v[164:167], a[4:7], a[36:39], v[164:167]
    ds_read_b128 a[72:75], v35 offset:32768
    s_add_u32 s73, s54, 262144
    v_mfma_f32_16x16x32_bf16 v[168:171], a[4:7], a[40:43], v[168:171]
    ds_read_b128 a[76:79], v35 offset:34816
    buffer_load_dwordx4 v4, s[8:11], s73 offen lds
    v_mfma_f32_16x16x32_bf16 v[172:175], a[4:7], a[44:47], v[172:175]
    ds_read_b64_tr_b16 a[24:25], v22 offset:0
    s_addk_i32 m0, 0x400
    v_mfma_f32_16x16x32_bf16 v[176:179], a[4:7], a[48:51], v[176:179]
    ds_read_b64_tr_b16 a[26:27], v22 offset:512
    buffer_load_dwordx4 v5, s[8:11], s73 offen lds
    v_mfma_f32_16x16x32_bf16 v[180:183], a[4:7], a[52:55], v[180:183]
    s_addk_i32 m0, 0x400
    v_mfma_f32_16x16x32_bf16 v[184:187], a[4:7], a[56:59], v[184:187]
    ds_read_b128 a[80:83], v37 offset:32768
    buffer_load_dwordx4 v6, s[8:11], s73 offen lds
    v_mfma_f32_16x16x32_bf16 v[188:191], a[4:7], a[60:63], v[188:191]
    ds_read_b128 a[84:87], v37 offset:34816
    s_addk_i32 m0, 0x400
    v_mfma_f32_16x16x32_bf16 v[192:195], a[8:11], a[32:35], v[192:195]
    ds_read_b64_tr_b16 a[28:29], v23 offset:0
    buffer_load_dwordx4 v7, s[8:11], s73 offen lds
    v_mfma_f32_16x16x32_bf16 v[196:199], a[8:11], a[36:39], v[196:199]
    s_add_u32 m0, s42, 16384
    v_mfma_f32_16x16x32_bf16 v[200:203], a[8:11], a[40:43], v[200:203]
    ds_read_b64_tr_b16 a[30:31], v23 offset:512
    buffer_load_dwordx4 v8, s[4:7], s48 offen lds
    v_mfma_f32_16x16x32_bf16 v[204:207], a[8:11], a[44:47], v[204:207]
    ds_read_b128 a[88:91], v39 offset:32768
    s_addk_i32 m0, 0x400
    v_mfma_f32_16x16x32_bf16 v[208:211], a[8:11], a[48:51], v[208:211]
    ds_read_b128 a[92:95], v39 offset:34816
    buffer_load_dwordx4 v9, s[4:7], s48 offen lds
    v_mfma_f32_16x16x32_bf16 v[212:215], a[8:11], a[52:55], v[212:215]
    v_mfma_f32_16x16x32_bf16 v[216:219], a[8:11], a[56:59], v[216:219]
    v_mfma_f32_16x16x32_bf16 v[220:223], a[8:11], a[60:63], v[220:223]
    v_mfma_f32_16x16x32_bf16 v[224:227], a[12:15], a[32:35], v[224:227]
    v_mfma_f32_16x16x32_bf16 v[228:231], a[12:15], a[36:39], v[228:231]
    v_mfma_f32_16x16x32_bf16 v[232:235], a[12:15], a[40:43], v[232:235]
    v_mfma_f32_16x16x32_bf16 v[236:239], a[12:15], a[44:47], v[236:239]
    v_mfma_f32_16x16x32_bf16 v[240:243], a[12:15], a[48:51], v[240:243]
    v_mfma_f32_16x16x32_bf16 v[244:247], a[12:15], a[52:55], v[244:247]
    v_mfma_f32_16x16x32_bf16 v[248:251], a[12:15], a[56:59], v[248:251]
    v_mfma_f32_16x16x32_bf16 v[252:255], a[12:15], a[60:63], v[252:255]
    s_waitcnt lgkmcnt(0)
    v_mfma_f32_16x16x32_bf16 v[128:131], a[16:19], a[64:67], v[128:131]
    v_mfma_f32_16x16x32_bf16 v[132:135], a[16:19], a[68:71], v[132:135]
    v_mfma_f32_16x16x32_bf16 v[136:139], a[16:19], a[72:75], v[136:139]
    s_waitcnt vmcnt(18)
    s_waitcnt vmcnt(14)
    s_barrier
    s_waitcnt vmcnt(6)
    s_addk_i32 m0, 0x400
    s_nop 0
    buffer_load_dwordx4 v10, s[4:7], s48 offen lds
    v_mfma_f32_16x16x32_bf16 v[140:143], a[16:19], a[76:79], v[140:143]
    s_addk_i32 m0, 0x400
    v_mfma_f32_16x16x32_bf16 v[144:147], a[16:19], a[80:83], v[144:147]
    ds_read_b64_tr_b16 a[0:1], v20 offset:4096
    ds_read_b64_tr_b16 a[2:3], v20 offset:4608
    buffer_load_dwordx4 v11, s[4:7], s48 offen lds
    v_mfma_f32_16x16x32_bf16 v[148:151], a[16:19], a[84:87], v[148:151]
    ds_read_b128 a[32:35], v32 offset:0
    s_add_u32 m0, s41, 12288
    v_mfma_f32_16x16x32_bf16 v[152:155], a[16:19], a[88:91], v[152:155]
    ds_read_b128 a[36:39], v32 offset:2048
    ds_read_b64_tr_b16 a[4:5], v21 offset:4096
    s_mov_b32 s73, s55
    v_mfma_f32_16x16x32_bf16 v[156:159], a[16:19], a[92:95], v[156:159]
    ds_read_b64_tr_b16 a[6:7], v21 offset:4608
    ds_read_b128 a[40:43], v34 offset:0
    buffer_load_dwordx4 v4, s[8:11], s73 offen lds
    v_mfma_f32_16x16x32_bf16 v[160:163], a[20:23], a[64:67], v[160:163]
    ds_read_b128 a[44:47], v34 offset:2048
    s_addk_i32 m0, 0x400
    v_mfma_f32_16x16x32_bf16 v[164:167], a[20:23], a[68:71], v[164:167]
    ds_read_b64_tr_b16 a[8:9], v22 offset:4096
    ds_read_b64_tr_b16 a[10:11], v22 offset:4608
    buffer_load_dwordx4 v5, s[8:11], s73 offen lds
    v_mfma_f32_16x16x32_bf16 v[168:171], a[20:23], a[72:75], v[168:171]
    ds_read_b128 a[48:51], v36 offset:0
    ds_read_b128 a[52:55], v36 offset:2048
    s_addk_i32 m0, 0x400
    v_mfma_f32_16x16x32_bf16 v[172:175], a[20:23], a[76:79], v[172:175]
    ds_read_b64_tr_b16 a[12:13], v23 offset:4096
    ds_read_b64_tr_b16 a[14:15], v23 offset:4608
    buffer_load_dwordx4 v6, s[8:11], s73 offen lds
    v_mfma_f32_16x16x32_bf16 v[176:179], a[20:23], a[80:83], v[176:179]
    ds_read_b128 a[56:59], v38 offset:0
    s_addk_i32 m0, 0x400
    v_mfma_f32_16x16x32_bf16 v[180:183], a[20:23], a[84:87], v[180:183]
    ds_read_b128 a[60:63], v38 offset:2048
    ds_read_b64 a[192:193], v40 offset:20480
    buffer_load_dwordx4 v7, s[8:11], s73 offen lds
    v_mfma_f32_16x16x32_bf16 v[184:187], a[20:23], a[88:91], v[184:187]
    ds_read_b64 a[194:195], v41 offset:20480
    ds_read_b64 a[196:197], v40 offset:22528
    s_addk_i32 m0, 0x400
    v_mfma_f32_16x16x32_bf16 v[188:191], a[20:23], a[92:95], v[188:191]
    ds_read_b64 a[198:199], v41 offset:22528
    s_add_u32 s73, s55, 262144
    v_mfma_f32_16x16x32_bf16 v[192:195], a[24:27], a[64:67], v[192:195]
    ds_read_b64 a[200:201], v42 offset:20480
    ds_read_b64 a[202:203], v43 offset:20480
    buffer_load_dwordx4 v4, s[8:11], s73 offen lds
    v_mfma_f32_16x16x32_bf16 v[196:199], a[24:27], a[68:71], v[196:199]
    ds_read_b64 a[204:205], v42 offset:22528
    ds_read_b64 a[206:207], v43 offset:22528
    s_addk_i32 m0, 0x400
    v_mfma_f32_16x16x32_bf16 v[200:203], a[24:27], a[72:75], v[200:203]
    ds_read_b64 a[208:209], v40 offset:24576
    ds_read_b64 a[210:211], v41 offset:24576
    buffer_load_dwordx4 v5, s[8:11], s73 offen lds
    v_mfma_f32_16x16x32_bf16 v[204:207], a[24:27], a[76:79], v[204:207]
    ds_read_b64 a[212:213], v40 offset:26624
    s_addk_i32 m0, 0x400
    v_mfma_f32_16x16x32_bf16 v[208:211], a[24:27], a[80:83], v[208:211]
    ds_read_b64 a[214:215], v41 offset:26624
    ds_read_b64 a[216:217], v42 offset:24576
    buffer_load_dwordx4 v6, s[8:11], s73 offen lds
    v_mfma_f32_16x16x32_bf16 v[212:215], a[24:27], a[84:87], v[212:215]
    ds_read_b64 a[218:219], v43 offset:24576
    ds_read_b64 a[220:221], v42 offset:26624
    s_addk_i32 m0, 0x400
    v_mfma_f32_16x16x32_bf16 v[216:219], a[24:27], a[88:91], v[216:219]
    ds_read_b64 a[222:223], v43 offset:26624
    buffer_load_dwordx4 v7, s[8:11], s73 offen lds
    v_mfma_f32_16x16x32_bf16 v[220:223], a[24:27], a[92:95], v[220:223]
    v_mfma_f32_16x16x32_bf16 v[224:227], a[28:31], a[64:67], v[224:227]
    v_mfma_f32_16x16x32_bf16 v[228:231], a[28:31], a[68:71], v[228:231]
    v_mfma_f32_16x16x32_bf16 v[232:235], a[28:31], a[72:75], v[232:235]
    v_mfma_f32_16x16x32_bf16 v[236:239], a[28:31], a[76:79], v[236:239]
    v_mfma_f32_16x16x32_bf16 v[240:243], a[28:31], a[80:83], v[240:243]
    v_mfma_f32_16x16x32_bf16 v[244:247], a[28:31], a[84:87], v[244:247]
    v_mfma_f32_16x16x32_bf16 v[248:251], a[28:31], a[88:91], v[248:251]
    v_mfma_f32_16x16x32_bf16 v[252:255], a[28:31], a[92:95], v[252:255]
    s_waitcnt lgkmcnt(0)
    v_mfma_f32_16x16x32_bf16 v[128:131], a[0:3], a[32:35], v[128:131]
    s_waitcnt vmcnt(12)
    s_add_u32 m0, s42, 32768
    v_mfma_f32_16x16x32_bf16 v[132:135], a[0:3], a[36:39], v[132:135]
    ds_read_b64_tr_b16 a[16:17], v20 offset:8192
    buffer_load_dwordx4 v8, s[4:7], s49 offen lds
    v_mfma_f32_16x16x32_bf16 v[136:139], a[0:3], a[40:43], v[136:139]
    ds_read_b64_tr_b16 a[18:19], v20 offset:8704
    s_addk_i32 m0, 0x400
    v_mfma_f32_16x16x32_bf16 v[140:143], a[0:3], a[44:47], v[140:143]
    ds_read_b128 a[64:67], v33 offset:0
    buffer_load_dwordx4 v9, s[4:7], s49 offen lds
    v_mfma_f32_16x16x32_bf16 v[144:147], a[0:3], a[48:51], v[144:147]
    s_addk_i32 m0, 0x400
    v_mfma_f32_16x16x32_bf16 v[148:151], a[0:3], a[52:55], v[148:151]
    ds_read_b128 a[68:71], v33 offset:2048
    buffer_load_dwordx4 v10, s[4:7], s49 offen lds
    v_mfma_f32_16x16x32_bf16 v[152:155], a[0:3], a[56:59], v[152:155]
    ds_read_b64_tr_b16 a[20:21], v21 offset:8192
    s_addk_i32 m0, 0x400
    v_mfma_f32_16x16x32_bf16 v[156:159], a[0:3], a[60:63], v[156:159]
    ds_read_b64_tr_b16 a[22:23], v21 offset:8704
    buffer_load_dwordx4 v11, s[4:7], s49 offen lds
    v_mfma_f32_16x16x32_bf16 v[160:163], a[4:7], a[32:35], v[160:163]
    s_add_u32 m0, s41, 0
    v_mfma_f32_16x16x32_bf16 v[164:167], a[4:7], a[36:39], v[164:167]
    ds_read_b128 a[72:75], v35 offset:0
    s_mov_b32 s73, s56
    v_mfma_f32_16x16x32_bf16 v[168:171], a[4:7], a[40:43], v[168:171]
    ds_read_b128 a[76:79], v35 offset:2048
    buffer_load_dwordx4 v4, s[8:11], s73 offen lds
    v_mfma_f32_16x16x32_bf16 v[172:175], a[4:7], a[44:47], v[172:175]
    ds_read_b64_tr_b16 a[24:25], v22 offset:8192
    s_addk_i32 m0, 0x400
    v_mfma_f32_16x16x32_bf16 v[176:179], a[4:7], a[48:51], v[176:179]
    ds_read_b64_tr_b16 a[26:27], v22 offset:8704
    buffer_load_dwordx4 v5, s[8:11], s73 offen lds
    v_mfma_f32_16x16x32_bf16 v[180:183], a[4:7], a[52:55], v[180:183]
    s_addk_i32 m0, 0x400
    v_mfma_f32_16x16x32_bf16 v[184:187], a[4:7], a[56:59], v[184:187]
    ds_read_b128 a[80:83], v37 offset:0
    buffer_load_dwordx4 v6, s[8:11], s73 offen lds
    v_mfma_f32_16x16x32_bf16 v[188:191], a[4:7], a[60:63], v[188:191]
    ds_read_b128 a[84:87], v37 offset:2048
    s_addk_i32 m0, 0x400
    v_mfma_f32_16x16x32_bf16 v[192:195], a[8:11], a[32:35], v[192:195]
    ds_read_b64_tr_b16 a[28:29], v23 offset:8192
    buffer_load_dwordx4 v7, s[8:11], s73 offen lds
    v_mfma_f32_16x16x32_bf16 v[196:199], a[8:11], a[36:39], v[196:199]
    s_add_u32 m0, s41, 20480
    v_mfma_f32_16x16x32_bf16 v[200:203], a[8:11], a[40:43], v[200:203]
    ds_read_b64_tr_b16 a[30:31], v23 offset:8704
    buffer_load_dwordx4 v12, s[12:15], s60 offen lds
    v_mfma_f32_16x16x32_bf16 v[204:207], a[8:11], a[44:47], v[204:207]
    ds_read_b128 a[88:91], v39 offset:0
    s_addk_i32 m0, 0x400
    v_mfma_f32_16x16x32_bf16 v[208:211], a[8:11], a[48:51], v[208:211]
    ds_read_b128 a[92:95], v39 offset:2048
    buffer_load_dwordx4 v13, s[12:15], s60 offen lds
    v_mfma_f32_16x16x32_bf16 v[212:215], a[8:11], a[52:55], v[212:215]
    v_mfma_f32_16x16x32_bf16 v[216:219], a[8:11], a[56:59], v[216:219]
    v_mfma_f32_16x16x32_bf16 v[220:223], a[8:11], a[60:63], v[220:223]
    v_mfma_f32_16x16x32_bf16 v[224:227], a[12:15], a[32:35], v[224:227]
    v_mfma_f32_16x16x32_bf16 v[228:231], a[12:15], a[36:39], v[228:231]
    v_mfma_f32_16x16x32_bf16 v[232:235], a[12:15], a[40:43], v[232:235]
    v_mfma_f32_16x16x32_bf16 v[236:239], a[12:15], a[44:47], v[236:239]
    v_mfma_f32_16x16x32_bf16 v[240:243], a[12:15], a[48:51], v[240:243]
    v_mfma_f32_16x16x32_bf16 v[244:247], a[12:15], a[52:55], v[244:247]
    v_mfma_f32_16x16x32_bf16 v[248:251], a[12:15], a[56:59], v[248:251]
    v_mfma_f32_16x16x32_bf16 v[252:255], a[12:15], a[60:63], v[252:255]
    s_waitcnt lgkmcnt(0)
    v_mfma_f32_16x16x32_bf16 v[128:131], a[16:19], a[64:67], v[128:131]
    v_mfma_f32_16x16x32_bf16 v[132:135], a[16:19], a[68:71], v[132:135]
    v_mfma_f32_16x16x32_bf16 v[136:139], a[16:19], a[72:75], v[136:139]
    s_waitcnt vmcnt(18)
    s_waitcnt vmcnt(14)
    s_barrier
    s_addk_i32 m0, 0x400
    v_mfma_f32_16x16x32_bf16 v[140:143], a[16:19], a[76:79], v[140:143]
    buffer_load_dwordx4 v14, s[12:15], s60 offen lds
    v_mfma_f32_16x16x32_bf16 v[144:147], a[16:19], a[80:83], v[144:147]
    s_addk_i32 m0, 0x400
    v_mfma_f32_16x16x32_bf16 v[148:151], a[16:19], a[84:87], v[148:151]
    ds_read_b64_tr_b16 a[0:1], v20 offset:12288
    buffer_load_dwordx4 v15, s[12:15], s60 offen lds
    v_mfma_f32_16x16x32_bf16 v[152:155], a[16:19], a[88:91], v[152:155]
    ds_read_b64_tr_b16 a[2:3], v20 offset:12800
    s_addk_i32 m0, 0x400
    v_mfma_f32_16x16x32_bf16 v[156:159], a[16:19], a[92:95], v[156:159]
    ds_read_b128 a[32:35], v32 offset:16384
    buffer_load_dwordx4 v12, s[12:15], s61 offen lds
    v_mfma_f32_16x16x32_bf16 v[160:163], a[20:23], a[64:67], v[160:163]
    ds_read_b128 a[36:39], v32 offset:18432
    s_addk_i32 m0, 0x400
    v_mfma_f32_16x16x32_bf16 v[164:167], a[20:23], a[68:71], v[164:167]
    ds_read_b64_tr_b16 a[4:5], v21 offset:12288
    buffer_load_dwordx4 v13, s[12:15], s61 offen lds
    v_mfma_f32_16x16x32_bf16 v[168:171], a[20:23], a[72:75], v[168:171]
    ds_read_b64_tr_b16 a[6:7], v21 offset:12800
    s_addk_i32 m0, 0x400
    v_mfma_f32_16x16x32_bf16 v[172:175], a[20:23], a[76:79], v[172:175]
    ds_read_b128 a[40:43], v34 offset:16384
    buffer_load_dwordx4 v14, s[12:15], s61 offen lds
    v_mfma_f32_16x16x32_bf16 v[176:179], a[20:23], a[80:83], v[176:179]
    s_addk_i32 m0, 0x400
    v_mfma_f32_16x16x32_bf16 v[180:183], a[20:23], a[84:87], v[180:183]
    ds_read_b128 a[44:47], v34 offset:18432
    buffer_load_dwordx4 v15, s[12:15], s61 offen lds
    v_mfma_f32_16x16x32_bf16 v[184:187], a[20:23], a[88:91], v[184:187]
    ds_read_b64_tr_b16 a[8:9], v22 offset:12288
    s_add_u32 m0, s41, 4096
    v_mfma_f32_16x16x32_bf16 v[188:191], a[20:23], a[92:95], v[188:191]
    ds_read_b64_tr_b16 a[10:11], v22 offset:12800
    s_add_u32 s73, s56, 262144
    v_mfma_f32_16x16x32_bf16 v[192:195], a[24:27], a[64:67], v[192:195]
    ds_read_b128 a[48:51], v36 offset:16384
    buffer_load_dwordx4 v4, s[8:11], s73 offen lds
    v_mfma_f32_16x16x32_bf16 v[196:199], a[24:27], a[68:71], v[196:199]
    ds_read_b128 a[52:55], v36 offset:18432
    s_addk_i32 m0, 0x400
    v_mfma_f32_16x16x32_bf16 v[200:203], a[24:27], a[72:75], v[200:203]
    ds_read_b64_tr_b16 a[12:13], v23 offset:12288
    buffer_load_dwordx4 v5, s[8:11], s73 offen lds
    v_mfma_f32_16x16x32_bf16 v[204:207], a[24:27], a[76:79], v[204:207]
    ds_read_b64_tr_b16 a[14:15], v23 offset:12800
    s_addk_i32 m0, 0x400
    v_mfma_f32_16x16x32_bf16 v[208:211], a[24:27], a[80:83], v[208:211]
    ds_read_b128 a[56:59], v38 offset:16384
    buffer_load_dwordx4 v6, s[8:11], s73 offen lds
    v_mfma_f32_16x16x32_bf16 v[212:215], a[24:27], a[84:87], v[212:215]
    ds_read_b128 a[60:63], v38 offset:18432
    s_addk_i32 m0, 0x400
    v_mfma_f32_16x16x32_bf16 v[216:219], a[24:27], a[88:91], v[216:219]
    buffer_load_dwordx4 v7, s[8:11], s73 offen lds
    v_mfma_f32_16x16x32_bf16 v[220:223], a[24:27], a[92:95], v[220:223]
    v_mfma_f32_16x16x32_bf16 v[224:227], a[28:31], a[64:67], v[224:227]
    v_mfma_f32_16x16x32_bf16 v[228:231], a[28:31], a[68:71], v[228:231]
    v_mfma_f32_16x16x32_bf16 v[232:235], a[28:31], a[72:75], v[232:235]
    v_mfma_f32_16x16x32_bf16 v[236:239], a[28:31], a[76:79], v[236:239]
    v_mfma_f32_16x16x32_bf16 v[240:243], a[28:31], a[80:83], v[240:243]
    v_mfma_f32_16x16x32_bf16 v[244:247], a[28:31], a[84:87], v[244:247]
    v_mfma_f32_16x16x32_bf16 v[248:251], a[28:31], a[88:91], v[248:251]
    v_mfma_f32_16x16x32_bf16 v[252:255], a[28:31], a[92:95], v[252:255]
    s_waitcnt lgkmcnt(0)
    v_mfma_f32_16x16x32_bf16 v[128:131], a[0:3], a[32:35], v[128:131]
    s_waitcnt vmcnt(20)
    s_waitcnt vmcnt(4)
    s_add_u32 m0, s42, 0
    v_mfma_f32_16x16x32_bf16 v[132:135], a[0:3], a[36:39], v[132:135]
    ds_read_b64_tr_b16 a[16:17], v20 offset:16384
    ds_read_b64_tr_b16 a[18:19], v20 offset:16896
    buffer_load_dwordx4 v8, s[4:7], s50 offen lds
    v_mfma_f32_16x16x32_bf16 v[136:139], a[0:3], a[40:43], v[136:139]
    ds_read_b128 a[64:67], v33 offset:16384
    s_addk_i32 m0, 0x400
    v_mfma_f32_16x16x32_bf16 v[140:143], a[0:3], a[44:47], v[140:143]
    ds_read_b128 a[68:71], v33 offset:18432
    ds_read_b64_tr_b16 a[20:21], v21 offset:16384
    buffer_load_dwordx4 v9, s[4:7], s50 offen lds
    v_mfma_f32_16x16x32_bf16 v[144:147], a[0:3], a[48:51], v[144:147]
    ds_read_b64_tr_b16 a[22:23], v21 offset:16896
    s_addk_i32 m0, 0x400
    v_mfma_f32_16x16x32_bf16 v[148:151], a[0:3], a[52:55], v[148:151]
    ds_read_b128 a[72:75], v35 offset:16384
    ds_read_b128 a[76:79], v35 offset:18432
    buffer_load_dwordx4 v10, s[4:7], s50 offen lds
    v_mfma_f32_16x16x32_bf16 v[152:155], a[0:3], a[56:59], v[152:155]
    ds_read_b64_tr_b16 a[24:25], v22 offset:16384
    s_addk_i32 m0, 0x400
    v_mfma_f32_16x16x32_bf16 v[156:159], a[0:3], a[60:63], v[156:159]
    ds_read_b64_tr_b16 a[26:27], v22 offset:16896
    ds_read_b128 a[80:83], v37 offset:16384
    buffer_load_dwordx4 v11, s[4:7], s50 offen lds
    v_mfma_f32_16x16x32_bf16 v[160:163], a[4:7], a[32:35], v[160:163]
    ds_read_b128 a[84:87], v37 offset:18432
    s_add_u32 m0, s41, 8192
    v_mfma_f32_16x16x32_bf16 v[164:167], a[4:7], a[36:39], v[164:167]
    ds_read_b64_tr_b16 a[28:29], v23 offset:16384
    ds_read_b64_tr_b16 a[30:31], v23 offset:16896
    s_mov_b32 s73, s57
    v_mfma_f32_16x16x32_bf16 v[168:171], a[4:7], a[40:43], v[168:171]
    ds_read_b128 a[88:91], v39 offset:16384
    buffer_load_dwordx4 v4, s[8:11], s73 offen lds
    v_mfma_f32_16x16x32_bf16 v[172:175], a[4:7], a[44:47], v[172:175]
    ds_read_b128 a[92:95], v39 offset:18432
    ds_read_b64 a[224:225], v40 offset:20480
    s_addk_i32 m0, 0x400
    v_mfma_f32_16x16x32_bf16 v[176:179], a[4:7], a[48:51], v[176:179]
    ds_read_b64 a[226:227], v41 offset:20480
    ds_read_b64 a[228:229], v40 offset:22528
    buffer_load_dwordx4 v5, s[8:11], s73 offen lds
    v_mfma_f32_16x16x32_bf16 v[180:183], a[4:7], a[52:55], v[180:183]
    ds_read_b64 a[230:231], v41 offset:22528
    s_addk_i32 m0, 0x400
    v_mfma_f32_16x16x32_bf16 v[184:187], a[4:7], a[56:59], v[184:187]
    ds_read_b64 a[232:233], v42 offset:20480
    ds_read_b64 a[234:235], v43 offset:20480
    buffer_load_dwordx4 v6, s[8:11], s73 offen lds
    v_mfma_f32_16x16x32_bf16 v[188:191], a[4:7], a[60:63], v[188:191]
    ds_read_b64 a[236:237], v42 offset:22528
    s_addk_i32 m0, 0x400
    v_mfma_f32_16x16x32_bf16 v[192:195], a[8:11], a[32:35], v[192:195]
    ds_read_b64 a[238:239], v43 offset:22528
    ds_read_b64 a[240:241], v40 offset:24576
    buffer_load_dwordx4 v7, s[8:11], s73 offen lds
    v_mfma_f32_16x16x32_bf16 v[196:199], a[8:11], a[36:39], v[196:199]
    ds_read_b64 a[242:243], v41 offset:24576
    s_addk_i32 m0, 0x400
    v_mfma_f32_16x16x32_bf16 v[200:203], a[8:11], a[40:43], v[200:203]
    ds_read_b64 a[244:245], v40 offset:26624
    ds_read_b64 a[246:247], v41 offset:26624
    s_add_u32 s73, s57, 262144
    v_mfma_f32_16x16x32_bf16 v[204:207], a[8:11], a[44:47], v[204:207]
    ds_read_b64 a[248:249], v42 offset:24576
    buffer_load_dwordx4 v4, s[8:11], s73 offen lds
    v_mfma_f32_16x16x32_bf16 v[208:211], a[8:11], a[48:51], v[208:211]
    ds_read_b64 a[250:251], v43 offset:24576
    ds_read_b64 a[252:253], v42 offset:26624
    s_addk_i32 m0, 0x400
    v_mfma_f32_16x16x32_bf16 v[212:215], a[8:11], a[52:55], v[212:215]
    ds_read_b64 a[254:255], v43 offset:26624
    buffer_load_dwordx4 v5, s[8:11], s73 offen lds
    v_mfma_f32_16x16x32_bf16 v[216:219], a[8:11], a[56:59], v[216:219]
    v_mfma_f32_16x16x32_bf16 v[220:223], a[8:11], a[60:63], v[220:223]
    v_mfma_f32_16x16x32_bf16 v[224:227], a[12:15], a[32:35], v[224:227]
    v_mfma_f32_16x16x32_bf16 v[228:231], a[12:15], a[36:39], v[228:231]
    v_mfma_f32_16x16x32_bf16 v[232:235], a[12:15], a[40:43], v[232:235]
    v_mfma_f32_16x16x32_bf16 v[236:239], a[12:15], a[44:47], v[236:239]
    v_mfma_f32_16x16x32_bf16 v[240:243], a[12:15], a[48:51], v[240:243]
    v_mfma_f32_16x16x32_bf16 v[244:247], a[12:15], a[52:55], v[244:247]
    v_mfma_f32_16x16x32_bf16 v[248:251], a[12:15], a[56:59], v[248:251]
    v_mfma_f32_16x16x32_bf16 v[252:255], a[12:15], a[60:63], v[252:255]
    s_waitcnt lgkmcnt(0)
    v_mfma_f32_16x16x32_bf16 v[128:131], a[16:19], a[64:67], v[128:131]
    v_mfma_f32_16x16x32_bf16 v[132:135], a[16:19], a[68:71], v[132:135]
    v_mfma_f32_16x16x32_bf16 v[136:139], a[16:19], a[72:75], v[136:139]
    s_barrier
    s_addk_i32 m0, 0x400
    v_mfma_f32_16x16x32_bf16 v[140:143], a[16:19], a[76:79], v[140:143]
    ds_read_b64_tr_b16 a[0:1], v20 offset:0
    buffer_load_dwordx4 v6, s[8:11], s73 offen lds
    v_mfma_f32_16x16x32_bf16 v[144:147], a[16:19], a[80:83], v[144:147]
    ds_read_b64_tr_b16 a[2:3], v20 offset:512
    s_addk_i32 m0, 0x400
    v_mfma_f32_16x16x32_bf16 v[148:151], a[16:19], a[84:87], v[148:151]
    ds_read_b128 a[32:35], v32 offset:32768
    buffer_load_dwordx4 v7, s[8:11], s73 offen lds
    v_mfma_f32_16x16x32_bf16 v[152:155], a[16:19], a[88:91], v[152:155]
    ds_read_b128 a[36:39], v32 offset:34816
    s_addk_i32 m0, 0x400
    v_mfma_f32_16x16x32_bf16 v[156:159], a[16:19], a[92:95], v[156:159]
    s_add_u32 s74, s70, s62
    v_mfma_f32_16x16x32_bf16 v[160:163], a[20:23], a[64:67], v[160:163]
    ds_read_b64_tr_b16 a[4:5], v21 offset:0
    v_mfma_f32_16x16x32_bf16 v[164:167], a[20:23], a[68:71], v[164:167]
    ds_read_b64_tr_b16 a[6:7], v21 offset:512
    buffer_load_dwordx4 v12, s[16:19], s74 offen lds
    v_mfma_f32_16x16x32_bf16 v[168:171], a[20:23], a[72:75], v[168:171]
    ds_read_b128 a[40:43], v34 offset:32768
    s_addk_i32 m0, 0x400
    v_mfma_f32_16x16x32_bf16 v[172:175], a[20:23], a[76:79], v[172:175]
    ds_read_b128 a[44:47], v34 offset:34816
    buffer_load_dwordx4 v13, s[16:19], s74 offen lds
    v_mfma_f32_16x16x32_bf16 v[176:179], a[20:23], a[80:83], v[176:179]
    s_addk_i32 m0, 0x400
    v_mfma_f32_16x16x32_bf16 v[180:183], a[20:23], a[84:87], v[180:183]
    ds_read_b64_tr_b16 a[8:9], v22 offset:0
    buffer_load_dwordx4 v14, s[16:19], s74 offen lds
    v_mfma_f32_16x16x32_bf16 v[184:187], a[20:23], a[88:91], v[184:187]
    ds_read_b64_tr_b16 a[10:11], v22 offset:512
    s_addk_i32 m0, 0x400
    v_mfma_f32_16x16x32_bf16 v[188:191], a[20:23], a[92:95], v[188:191]
    ds_read_b128 a[48:51], v36 offset:32768
    v_mfma_f32_16x16x32_bf16 v[192:195], a[24:27], a[64:67], v[192:195]
    ds_read_b128 a[52:55], v36 offset:34816
    buffer_load_dwordx4 v15, s[16:19], s74 offen lds
    v_mfma_f32_16x16x32_bf16 v[196:199], a[24:27], a[68:71], v[196:199]
    s_addk_i32 m0, 0x400
    v_mfma_f32_16x16x32_bf16 v[200:203], a[24:27], a[72:75], v[200:203]
    ds_read_b64_tr_b16 a[12:13], v23 offset:0
    s_add_u32 s74, s71, s62
    v_mfma_f32_16x16x32_bf16 v[204:207], a[24:27], a[76:79], v[204:207]
    ds_read_b64_tr_b16 a[14:15], v23 offset:512
    buffer_load_dwordx4 v12, s[16:19], s74 offen lds
    v_mfma_f32_16x16x32_bf16 v[208:211], a[24:27], a[80:83], v[208:211]
    ds_read_b128 a[56:59], v38 offset:32768
    s_addk_i32 m0, 0x400
    v_mfma_f32_16x16x32_bf16 v[212:215], a[24:27], a[84:87], v[212:215]
    ds_read_b128 a[60:63], v38 offset:34816
    buffer_load_dwordx4 v13, s[16:19], s74 offen lds
    v_mfma_f32_16x16x32_bf16 v[216:219], a[24:27], a[88:91], v[216:219]
    v_mfma_f32_16x16x32_bf16 v[220:223], a[24:27], a[92:95], v[220:223]
    v_mfma_f32_16x16x32_bf16 v[224:227], a[28:31], a[64:67], v[224:227]
    v_mfma_f32_16x16x32_bf16 v[228:231], a[28:31], a[68:71], v[228:231]
    v_mfma_f32_16x16x32_bf16 v[232:235], a[28:31], a[72:75], v[232:235]
    v_mfma_f32_16x16x32_bf16 v[236:239], a[28:31], a[76:79], v[236:239]
    v_mfma_f32_16x16x32_bf16 v[240:243], a[28:31], a[80:83], v[240:243]
    v_mfma_f32_16x16x32_bf16 v[244:247], a[28:31], a[84:87], v[244:247]
    v_mfma_f32_16x16x32_bf16 v[248:251], a[28:31], a[88:91], v[248:251]
    v_mfma_f32_16x16x32_bf16 v[252:255], a[28:31], a[92:95], v[252:255]
    s_waitcnt lgkmcnt(0)
    v_mfma_f32_16x16x32_bf16 v[128:131], a[0:3], a[32:35], v[128:131]
    s_waitcnt vmcnt(18)
    s_addk_i32 m0, 0x400
    v_mfma_f32_16x16x32_bf16 v[132:135], a[0:3], a[36:39], v[132:135]
    ds_read_b64_tr_b16 a[16:17], v20 offset:4096
    buffer_load_dwordx4 v14, s[16:19], s74 offen lds
    v_mfma_f32_16x16x32_bf16 v[136:139], a[0:3], a[40:43], v[136:139]
    ds_read_b64_tr_b16 a[18:19], v20 offset:4608
    v_mfma_f32_16x16x32_bf16 v[140:143], a[0:3], a[44:47], v[140:143]
    ds_read_b128 a[64:67], v33 offset:32768
    s_addk_i32 m0, 0x400
    v_mfma_f32_16x16x32_bf16 v[144:147], a[0:3], a[48:51], v[144:147]
    buffer_load_dwordx4 v15, s[16:19], s74 offen lds
    v_mfma_f32_16x16x32_bf16 v[148:151], a[0:3], a[52:55], v[148:151]
    ds_read_b128 a[68:71], v33 offset:34816
    v_mfma_f32_16x16x32_bf16 v[152:155], a[0:3], a[56:59], v[152:155]
    ds_read_b64_tr_b16 a[20:21], v21 offset:4096
    s_addk_i32 m0, 0x400
    v_mfma_f32_16x16x32_bf16 v[156:159], a[0:3], a[60:63], v[156:159]
    ds_read_b64_tr_b16 a[22:23], v21 offset:4608
    s_add_u32 s88, s72, s66
    v_mfma_f32_16x16x32_bf16 v[160:163], a[4:7], a[32:35], v[160:163]
    v_mfma_f32_16x16x32_bf16 v[164:167], a[4:7], a[36:39], v[164:167]
    ds_read_b128 a[72:75], v35 offset:32768
    s_mov_b32 s75, s88
    v_mfma_f32_16x16x32_bf16 v[168:171], a[4:7], a[40:43], v[168:171]
    ds_read_b128 a[76:79], v35 offset:34816
    v_mfma_f32_16x16x32_bf16 v[172:175], a[4:7], a[44:47], v[172:175]
    ds_read_b64_tr_b16 a[24:25], v22 offset:4096
    buffer_load_dwordx4 v16, s[20:23], s75 offen lds
    v_mfma_f32_16x16x32_bf16 v[176:179], a[4:7], a[48:51], v[176:179]
    ds_read_b64_tr_b16 a[26:27], v22 offset:4608
    s_addk_i32 m0, 0x400
    v_mfma_f32_16x16x32_bf16 v[180:183], a[4:7], a[52:55], v[180:183]
    v_mfma_f32_16x16x32_bf16 v[184:187], a[4:7], a[56:59], v[184:187]
    ds_read_b128 a[80:83], v37 offset:32768
    buffer_load_dwordx4 v17, s[20:23], s75 offen lds
    v_mfma_f32_16x16x32_bf16 v[188:191], a[4:7], a[60:63], v[188:191]
    ds_read_b128 a[84:87], v37 offset:34816
    s_addk_i32 m0, 0x400
    v_mfma_f32_16x16x32_bf16 v[192:195], a[8:11], a[32:35], v[192:195]
    ds_read_b64_tr_b16 a[28:29], v23 offset:4096
    v_mfma_f32_16x16x32_bf16 v[196:199], a[8:11], a[36:39], v[196:199]
    buffer_load_dwordx4 v18, s[20:23], s75 offen lds
    v_mfma_f32_16x16x32_bf16 v[200:203], a[8:11], a[40:43], v[200:203]
    ds_read_b64_tr_b16 a[30:31], v23 offset:4608
    s_addk_i32 m0, 0x400
    v_mfma_f32_16x16x32_bf16 v[204:207], a[8:11], a[44:47], v[204:207]
    ds_read_b128 a[88:91], v39 offset:32768
    v_mfma_f32_16x16x32_bf16 v[208:211], a[8:11], a[48:51], v[208:211]
    ds_read_b128 a[92:95], v39 offset:34816
    buffer_load_dwordx4 v19, s[20:23], s75 offen lds
    v_mfma_f32_16x16x32_bf16 v[212:215], a[8:11], a[52:55], v[212:215]
    v_mfma_f32_16x16x32_bf16 v[216:219], a[8:11], a[56:59], v[216:219]
    v_mfma_f32_16x16x32_bf16 v[220:223], a[8:11], a[60:63], v[220:223]
    v_mfma_f32_16x16x32_bf16 v[224:227], a[12:15], a[32:35], v[224:227]
    v_mfma_f32_16x16x32_bf16 v[228:231], a[12:15], a[36:39], v[228:231]
    v_mfma_f32_16x16x32_bf16 v[232:235], a[12:15], a[40:43], v[232:235]
    v_mfma_f32_16x16x32_bf16 v[236:239], a[12:15], a[44:47], v[236:239]
    v_mfma_f32_16x16x32_bf16 v[240:243], a[12:15], a[48:51], v[240:243]
    v_mfma_f32_16x16x32_bf16 v[244:247], a[12:15], a[52:55], v[244:247]
    v_mfma_f32_16x16x32_bf16 v[248:251], a[12:15], a[56:59], v[248:251]
    v_mfma_f32_16x16x32_bf16 v[252:255], a[12:15], a[60:63], v[252:255]
    s_waitcnt lgkmcnt(0)
    v_mfma_f32_16x16x32_bf16 v[128:131], a[16:19], a[64:67], v[128:131]
    v_mfma_f32_16x16x32_bf16 v[132:135], a[16:19], a[68:71], v[132:135]
    v_mfma_f32_16x16x32_bf16 v[136:139], a[16:19], a[72:75], v[136:139]
    s_waitcnt vmcnt(20)
    s_waitcnt vmcnt(16)
    s_barrier
    s_add_u32 m0, s42, 16384
    v_mfma_f32_16x16x32_bf16 v[140:143], a[16:19], a[76:79], v[140:143]
    v_mfma_f32_16x16x32_bf16 v[144:147], a[16:19], a[80:83], v[144:147]
    s_add_u32 s75, s88, 229376
    v_mfma_f32_16x16x32_bf16 v[148:151], a[16:19], a[84:87], v[148:151]
    ds_read_b64_tr_b16 a[0:1], v20 offset:8192
    v_mfma_f32_16x16x32_bf16 v[152:155], a[16:19], a[88:91], v[152:155]
    ds_read_b64_tr_b16 a[2:3], v20 offset:8704
    buffer_load_dwordx4 v16, s[20:23], s75 offen lds
    v_mfma_f32_16x16x32_bf16 v[156:159], a[16:19], a[92:95], v[156:159]
    ds_read_b128 a[32:35], v32 offset:0
    v_mfma_f32_16x16x32_bf16 v[160:163], a[20:23], a[64:67], v[160:163]
    ds_read_b128 a[36:39], v32 offset:2048
    v_mfma_f32_16x16x32_bf16 v[164:167], a[20:23], a[68:71], v[164:167]
    ds_read_b64_tr_b16 a[4:5], v21 offset:8192
    s_addk_i32 m0, 0x400
    v_mfma_f32_16x16x32_bf16 v[168:171], a[20:23], a[72:75], v[168:171]
    ds_read_b64_tr_b16 a[6:7], v21 offset:8704
    v_mfma_f32_16x16x32_bf16 v[172:175], a[20:23], a[76:79], v[172:175]
    ds_read_b128 a[40:43], v34 offset:0
    buffer_load_dwordx4 v17, s[20:23], s75 offen lds
    v_mfma_f32_16x16x32_bf16 v[176:179], a[20:23], a[80:83], v[176:179]
    v_mfma_f32_16x16x32_bf16 v[180:183], a[20:23], a[84:87], v[180:183]
    ds_read_b128 a[44:47], v34 offset:2048
    s_addk_i32 m0, 0x400
    v_mfma_f32_16x16x32_bf16 v[184:187], a[20:23], a[88:91], v[184:187]
    ds_read_b64_tr_b16 a[8:9], v22 offset:8192
    v_mfma_f32_16x16x32_bf16 v[188:191], a[20:23], a[92:95], v[188:191]
    ds_read_b64_tr_b16 a[10:11], v22 offset:8704
    v_mfma_f32_16x16x32_bf16 v[192:195], a[24:27], a[64:67], v[192:195]
    ds_read_b128 a[48:51], v36 offset:0
    buffer_load_dwordx4 v18, s[20:23], s75 offen lds
    v_mfma_f32_16x16x32_bf16 v[196:199], a[24:27], a[68:71], v[196:199]
    ds_read_b128 a[52:55], v36 offset:2048
    v_mfma_f32_16x16x32_bf16 v[200:203], a[24:27], a[72:75], v[200:203]
    ds_read_b64_tr_b16 a[12:13], v23 offset:8192
    s_addk_i32 m0, 0x400
    v_mfma_f32_16x16x32_bf16 v[204:207], a[24:27], a[76:79], v[204:207]
    ds_read_b64_tr_b16 a[14:15], v23 offset:8704
    v_mfma_f32_16x16x32_bf16 v[208:211], a[24:27], a[80:83], v[208:211]
    ds_read_b128 a[56:59], v38 offset:0
    buffer_load_dwordx4 v19, s[20:23], s75 offen lds
    v_mfma_f32_16x16x32_bf16 v[212:215], a[24:27], a[84:87], v[212:215]
    ds_read_b128 a[60:63], v38 offset:2048
    v_mfma_f32_16x16x32_bf16 v[216:219], a[24:27], a[88:91], v[216:219]
    v_mfma_f32_16x16x32_bf16 v[220:223], a[24:27], a[92:95], v[220:223]
    v_mfma_f32_16x16x32_bf16 v[224:227], a[28:31], a[64:67], v[224:227]
    v_mfma_f32_16x16x32_bf16 v[228:231], a[28:31], a[68:71], v[228:231]
    v_mfma_f32_16x16x32_bf16 v[232:235], a[28:31], a[72:75], v[232:235]
    v_mfma_f32_16x16x32_bf16 v[236:239], a[28:31], a[76:79], v[236:239]
    v_mfma_f32_16x16x32_bf16 v[240:243], a[28:31], a[80:83], v[240:243]
    v_mfma_f32_16x16x32_bf16 v[244:247], a[28:31], a[84:87], v[244:247]
    v_mfma_f32_16x16x32_bf16 v[248:251], a[28:31], a[88:91], v[248:251]
    v_mfma_f32_16x16x32_bf16 v[252:255], a[28:31], a[92:95], v[252:255]
    s_waitcnt lgkmcnt(0)
    v_mfma_f32_16x16x32_bf16 v[128:131], a[0:3], a[32:35], v[128:131]
    s_waitcnt vmcnt(16)
    s_add_u32 m0, s41, 0
    v_mfma_f32_16x16x32_bf16 v[132:135], a[0:3], a[36:39], v[132:135]
    ds_read_b64_tr_b16 a[16:17], v20 offset:12288
    v_mfma_f32_16x16x32_bf16 v[136:139], a[0:3], a[40:43], v[136:139]
    ds_read_b64_tr_b16 a[18:19], v20 offset:12800
    s_add_u32 s75, s88, 28672
    v_mfma_f32_16x16x32_bf16 v[140:143], a[0:3], a[44:47], v[140:143]
    ds_read_b128 a[64:67], v33 offset:0
    v_mfma_f32_16x16x32_bf16 v[144:147], a[0:3], a[48:51], v[144:147]
    buffer_load_dwordx4 v16, s[20:23], s75 offen lds
    v_mfma_f32_16x16x32_bf16 v[148:151], a[0:3], a[52:55], v[148:151]
    ds_read_b128 a[68:71], v33 offset:2048
    v_mfma_f32_16x16x32_bf16 v[152:155], a[0:3], a[56:59], v[152:155]
    ds_read_b64_tr_b16 a[20:21], v21 offset:12288
    v_mfma_f32_16x16x32_bf16 v[156:159], a[0:3], a[60:63], v[156:159]
    ds_read_b64_tr_b16 a[22:23], v21 offset:12800
    s_addk_i32 m0, 0x400
    v_mfma_f32_16x16x32_bf16 v[160:163], a[4:7], a[32:35], v[160:163]
    v_mfma_f32_16x16x32_bf16 v[164:167], a[4:7], a[36:39], v[164:167]
    ds_read_b128 a[72:75], v35 offset:0
    buffer_load_dwordx4 v17, s[20:23], s75 offen lds
    v_mfma_f32_16x16x32_bf16 v[168:171], a[4:7], a[40:43], v[168:171]
    ds_read_b128 a[76:79], v35 offset:2048
    v_mfma_f32_16x16x32_bf16 v[172:175], a[4:7], a[44:47], v[172:175]
    ds_read_b64_tr_b16 a[24:25], v22 offset:12288
    v_mfma_f32_16x16x32_bf16 v[176:179], a[4:7], a[48:51], v[176:179]
    ds_read_b64_tr_b16 a[26:27], v22 offset:12800
    s_addk_i32 m0, 0x400
    v_mfma_f32_16x16x32_bf16 v[180:183], a[4:7], a[52:55], v[180:183]
    v_mfma_f32_16x16x32_bf16 v[184:187], a[4:7], a[56:59], v[184:187]
    ds_read_b128 a[80:83], v37 offset:0
    buffer_load_dwordx4 v18, s[20:23], s75 offen lds
    v_mfma_f32_16x16x32_bf16 v[188:191], a[4:7], a[60:63], v[188:191]
    ds_read_b128 a[84:87], v37 offset:2048
    v_mfma_f32_16x16x32_bf16 v[192:195], a[8:11], a[32:35], v[192:195]
    ds_read_b64_tr_b16 a[28:29], v23 offset:12288
    v_mfma_f32_16x16x32_bf16 v[196:199], a[8:11], a[36:39], v[196:199]
    s_addk_i32 m0, 0x400
    v_mfma_f32_16x16x32_bf16 v[200:203], a[8:11], a[40:43], v[200:203]
    ds_read_b64_tr_b16 a[30:31], v23 offset:12800
    v_mfma_f32_16x16x32_bf16 v[204:207], a[8:11], a[44:47], v[204:207]
    ds_read_b128 a[88:91], v39 offset:0
    buffer_load_dwordx4 v19, s[20:23], s75 offen lds
    v_mfma_f32_16x16x32_bf16 v[208:211], a[8:11], a[48:51], v[208:211]
    ds_read_b128 a[92:95], v39 offset:2048
    v_mfma_f32_16x16x32_bf16 v[212:215], a[8:11], a[52:55], v[212:215]
    v_mfma_f32_16x16x32_bf16 v[216:219], a[8:11], a[56:59], v[216:219]
    v_mfma_f32_16x16x32_bf16 v[220:223], a[8:11], a[60:63], v[220:223]
    v_mfma_f32_16x16x32_bf16 v[224:227], a[12:15], a[32:35], v[224:227]
    v_mfma_f32_16x16x32_bf16 v[228:231], a[12:15], a[36:39], v[228:231]
    v_mfma_f32_16x16x32_bf16 v[232:235], a[12:15], a[40:43], v[232:235]
    v_mfma_f32_16x16x32_bf16 v[236:239], a[12:15], a[44:47], v[236:239]
    v_mfma_f32_16x16x32_bf16 v[240:243], a[12:15], a[48:51], v[240:243]
    v_mfma_f32_16x16x32_bf16 v[244:247], a[12:15], a[52:55], v[244:247]
    v_mfma_f32_16x16x32_bf16 v[248:251], a[12:15], a[56:59], v[248:251]
    v_mfma_f32_16x16x32_bf16 v[252:255], a[12:15], a[60:63], v[252:255]
    s_waitcnt lgkmcnt(0)
    v_mfma_f32_16x16x32_bf16 v[128:131], a[16:19], a[64:67], v[128:131]
    v_mfma_f32_16x16x32_bf16 v[132:135], a[16:19], a[68:71], v[132:135]
    v_mfma_f32_16x16x32_bf16 v[136:139], a[16:19], a[72:75], v[136:139]
    s_barrier
    s_addk_i32 m0, 0x400
    v_mfma_f32_16x16x32_bf16 v[140:143], a[16:19], a[76:79], v[140:143]
    v_mfma_f32_16x16x32_bf16 v[144:147], a[16:19], a[80:83], v[144:147]
    s_add_u32 s75, s88, 258048
    v_mfma_f32_16x16x32_bf16 v[148:151], a[16:19], a[84:87], v[148:151]
    v_mfma_f32_16x16x32_bf16 v[152:155], a[16:19], a[88:91], v[152:155]
    buffer_load_dwordx4 v16, s[20:23], s75 offen lds
    v_mfma_f32_16x16x32_bf16 v[156:159], a[16:19], a[92:95], v[156:159]
    v_mfma_f32_16x16x32_bf16 v[160:163], a[20:23], a[64:67], v[160:163]
    v_mfma_f32_16x16x32_bf16 v[164:167], a[20:23], a[68:71], v[164:167]
    s_addk_i32 m0, 0x400
    v_mfma_f32_16x16x32_bf16 v[168:171], a[20:23], a[72:75], v[168:171]
    v_mfma_f32_16x16x32_bf16 v[172:175], a[20:23], a[76:79], v[172:175]
    buffer_load_dwordx4 v17, s[20:23], s75 offen lds
    v_mfma_f32_16x16x32_bf16 v[176:179], a[20:23], a[80:83], v[176:179]
    v_mfma_f32_16x16x32_bf16 v[180:183], a[20:23], a[84:87], v[180:183]
    s_addk_i32 m0, 0x400
    v_mfma_f32_16x16x32_bf16 v[184:187], a[20:23], a[88:91], v[184:187]
    v_mfma_f32_16x16x32_bf16 v[188:191], a[20:23], a[92:95], v[188:191]
    v_mfma_f32_16x16x32_bf16 v[192:195], a[24:27], a[64:67], v[192:195]
    buffer_load_dwordx4 v18, s[20:23], s75 offen lds
    v_mfma_f32_16x16x32_bf16 v[196:199], a[24:27], a[68:71], v[196:199]
    v_mfma_f32_16x16x32_bf16 v[200:203], a[24:27], a[72:75], v[200:203]
    s_addk_i32 m0, 0x400
    v_mfma_f32_16x16x32_bf16 v[204:207], a[24:27], a[76:79], v[204:207]
    v_mfma_f32_16x16x32_bf16 v[208:211], a[24:27], a[80:83], v[208:211]
    buffer_load_dwordx4 v19, s[20:23], s75 offen lds
    v_mfma_f32_16x16x32_bf16 v[212:215], a[24:27], a[84:87], v[212:215]
    v_mfma_f32_16x16x32_bf16 v[216:219], a[24:27], a[88:91], v[216:219]
    v_mfma_f32_16x16x32_bf16 v[220:223], a[24:27], a[92:95], v[220:223]
    v_mfma_f32_16x16x32_bf16 v[224:227], a[28:31], a[64:67], v[224:227]
    v_mfma_f32_16x16x32_bf16 v[228:231], a[28:31], a[68:71], v[228:231]
    v_mfma_f32_16x16x32_bf16 v[232:235], a[28:31], a[72:75], v[232:235]
    v_mfma_f32_16x16x32_bf16 v[236:239], a[28:31], a[76:79], v[236:239]
    v_mfma_f32_16x16x32_bf16 v[240:243], a[28:31], a[80:83], v[240:243]
    v_mfma_f32_16x16x32_bf16 v[244:247], a[28:31], a[84:87], v[244:247]
    v_mfma_f32_16x16x32_bf16 v[248:251], a[28:31], a[88:91], v[248:251]
    v_mfma_f32_16x16x32_bf16 v[252:255], a[28:31], a[92:95], v[252:255]
    v_cvt_pk_bf16_f32 v72, v136, v137
    v_cvt_pk_bf16_f32 v73, v138, v139
    v_cvt_pk_bf16_f32 v74, v168, v169
    v_cvt_pk_bf16_f32 v75, v170, v171
    v_cvt_pk_bf16_f32 v76, v140, v141
    v_cvt_pk_bf16_f32 v77, v142, v143
    v_cvt_pk_bf16_f32 v78, v172, v173
    v_cvt_pk_bf16_f32 v79, v174, v175
    v_cvt_pk_bf16_f32 v104, v200, v201
    v_cvt_pk_bf16_f32 v105, v202, v203
    v_cvt_pk_bf16_f32 v106, v232, v233
    v_cvt_pk_bf16_f32 v107, v234, v235
    v_cvt_pk_bf16_f32 v108, v204, v205
    v_cvt_pk_bf16_f32 v109, v206, v207
    v_cvt_pk_bf16_f32 v110, v236, v237
    v_cvt_pk_bf16_f32 v111, v238, v239
    v_mfma_f32_16x16x32_bf16 a[144:147], a[208:211], v[72:75], 0
    s_add_u32 m0, s42, 32768
    v_cvt_pk_bf16_f32 v80, v144, v145
    v_cvt_pk_bf16_f32 v81, v146, v147
    v_mfma_f32_16x16x32_bf16 a[148:151], a[208:211], v[76:79], 0
    s_add_u32 s74, s70, s63
    v_cvt_pk_bf16_f32 v82, v176, v177
    v_cvt_pk_bf16_f32 v83, v178, v179
    v_mfma_f32_16x16x32_bf16 a[152:155], a[212:215], v[72:75], 0
    v_cvt_pk_bf16_f32 v84, v148, v149
    v_cvt_pk_bf16_f32 v85, v150, v151
    v_mfma_f32_16x16x32_bf16 a[156:159], a[212:215], v[76:79], 0
    buffer_load_dwordx4 v12, s[16:19], s74 offen lds
    v_cvt_pk_bf16_f32 v86, v180, v181
    v_cvt_pk_bf16_f32 v87, v182, v183
    v_mfma_f32_16x16x32_bf16 a[144:147], a[216:219], v[104:107], a[144:147]
    v_cvt_pk_bf16_f32 v112, v208, v209
    v_cvt_pk_bf16_f32 v113, v210, v211
    v_mfma_f32_16x16x32_bf16 a[148:151], a[216:219], v[108:111], a[148:151]
    v_cvt_pk_bf16_f32 v114, v240, v241
    v_cvt_pk_bf16_f32 v115, v242, v243
    v_mfma_f32_16x16x32_bf16 a[152:155], a[220:223], v[104:107], a[152:155]
    v_cvt_pk_bf16_f32 v116, v212, v213
    v_cvt_pk_bf16_f32 v117, v214, v215
    v_mfma_f32_16x16x32_bf16 a[156:159], a[220:223], v[108:111], a[156:159]
    v_cvt_pk_bf16_f32 v118, v244, v245
    v_cvt_pk_bf16_f32 v119, v246, v247
    v_mfma_f32_16x16x32_bf16 a[160:163], a[224:227], v[80:83], 0
    s_addk_i32 m0, 0x400
    v_cvt_pk_bf16_f32 v88, v152, v153
    v_cvt_pk_bf16_f32 v89, v154, v155
    v_mfma_f32_16x16x32_bf16 a[164:167], a[224:227], v[84:87], 0
    v_cvt_pk_bf16_f32 v90, v184, v185
    v_cvt_pk_bf16_f32 v91, v186, v187
    v_mfma_f32_16x16x32_bf16 a[168:171], a[228:231], v[80:83], 0
    buffer_load_dwordx4 v13, s[16:19], s74 offen lds
    v_cvt_pk_bf16_f32 v92, v156, v157
    v_cvt_pk_bf16_f32 v93, v158, v159
    v_mfma_f32_16x16x32_bf16 a[172:175], a[228:231], v[84:87], 0
    v_cvt_pk_bf16_f32 v94, v188, v189
    v_cvt_pk_bf16_f32 v95, v190, v191
    v_mfma_f32_16x16x32_bf16 a[160:163], a[232:235], v[112:115], a[160:163]
    v_cvt_pk_bf16_f32 v120, v216, v217
    v_cvt_pk_bf16_f32 v121, v218, v219
    v_mfma_f32_16x16x32_bf16 a[164:167], a[232:235], v[116:119], a[164:167]
    v_cvt_pk_bf16_f32 v122, v248, v249
    v_cvt_pk_bf16_f32 v123, v250, v251
    v_mfma_f32_16x16x32_bf16 a[168:171], a[236:239], v[112:115], a[168:171]
    v_cvt_pk_bf16_f32 v124, v220, v221
    v_cvt_pk_bf16_f32 v125, v222, v223
    v_mfma_f32_16x16x32_bf16 a[172:175], a[236:239], v[116:119], a[172:175]
    v_cvt_pk_bf16_f32 v126, v252, v253
    v_cvt_pk_bf16_f32 v127, v254, v255
    v_mfma_f32_16x16x32_bf16 a[176:179], a[240:243], v[88:91], 0
    s_addk_i32 m0, 0x400
    v_cvt_pk_bf16_f32 v64, v128, v129
    v_cvt_pk_bf16_f32 v65, v130, v131
    v_cvt_pk_bf16_f32 v66, v160, v161
    v_mfma_f32_16x16x32_bf16 a[180:183], a[240:243], v[92:95], 0
    v_cvt_pk_bf16_f32 v67, v162, v163
    v_cvt_pk_bf16_f32 v68, v132, v133
    v_mfma_f32_16x16x32_bf16 a[184:187], a[244:247], v[88:91], 0
    buffer_load_dwordx4 v14, s[16:19], s74 offen lds
    v_cvt_pk_bf16_f32 v69, v134, v135
    v_cvt_pk_bf16_f32 v70, v164, v165
    v_cvt_pk_bf16_f32 v71, v166, v167
    v_mfma_f32_16x16x32_bf16 a[188:191], a[244:247], v[92:95], 0
    v_cvt_pk_bf16_f32 v96, v192, v193
    v_cvt_pk_bf16_f32 v97, v194, v195
    v_mfma_f32_16x16x32_bf16 a[176:179], a[248:251], v[120:123], a[176:179]
    v_cvt_pk_bf16_f32 v98, v224, v225
    v_cvt_pk_bf16_f32 v99, v226, v227
    v_cvt_pk_bf16_f32 v100, v196, v197
    v_mfma_f32_16x16x32_bf16 a[180:183], a[248:251], v[124:127], a[180:183]
    v_cvt_pk_bf16_f32 v101, v198, v199
    v_cvt_pk_bf16_f32 v102, v228, v229
    v_mfma_f32_16x16x32_bf16 a[184:187], a[252:255], v[120:123], a[184:187]
    v_cvt_pk_bf16_f32 v103, v230, v231
    ds_write_b128 v45, a[144:147] offset:0
    ds_write_b128 v45, a[148:151] offset:1024
    v_mfma_f32_16x16x32_bf16 a[188:191], a[252:255], v[124:127], a[188:191]
    ds_write_b128 v45, a[152:155] offset:2048
    ds_write_b128 v45, a[156:159] offset:3072
    v_mfma_f32_16x16x32_bf16 a[128:131], a[192:195], v[64:67], 0
    s_waitcnt vmcnt(11)
    ds_read_b128 a[0:3], v28 offset:16384
    ds_read_b128 a[4:7], v28 offset:18432
    ds_read_b128 a[8:11], v28 offset:20480
    ds_read_b128 a[12:15], v28 offset:22528
    s_addk_i32 m0, 0x400
    ds_write_b128 v46, a[160:163] offset:0
    v_mfma_f32_16x16x32_bf16 a[132:135], a[192:195], v[68:71], 0
    ds_read_b128 a[16:19], v29 offset:16384
    ds_read_b128 a[20:23], v29 offset:18432
    ds_read_b128 a[24:27], v29 offset:20480
    ds_read_b128 a[28:31], v29 offset:22528
    ds_read_b64_tr_b16 a[48:49], v20 offset:24576
    v_mfma_f32_16x16x32_bf16 a[136:139], a[196:199], v[64:67], 0
    ds_read_b64_tr_b16 a[50:51], v20 offset:25088
    ds_read_b64_tr_b16 a[52:53], v21 offset:24576
    ds_read_b64_tr_b16 a[54:55], v21 offset:25088
    ds_read_b64_tr_b16 a[56:57], v22 offset:24576
    ds_read_b64_tr_b16 a[58:59], v22 offset:25088
    buffer_load_dwordx4 v15, s[16:19], s74 offen lds
    ds_write_b128 v46, a[164:167] offset:1024
    v_mfma_f32_16x16x32_bf16 a[140:143], a[196:199], v[68:71], 0
    ds_read_b64_tr_b16 a[60:61], v23 offset:24576
    ds_read_b64_tr_b16 a[62:63], v23 offset:25088
    ds_read_b64_tr_b16 a[64:65], v24 offset:16384
    ds_read_b64_tr_b16 a[66:67], v24 offset:16896
    ds_read_b64_tr_b16 a[68:69], v25 offset:16384
    v_mfma_f32_16x16x32_bf16 a[128:131], a[200:203], v[96:99], a[128:131]
    ds_read_b64_tr_b16 a[70:71], v25 offset:16896
    ds_read_b64_tr_b16 a[72:73], v26 offset:16384
    ds_read_b64_tr_b16 a[74:75], v26 offset:16896
    ds_read_b64_tr_b16 a[76:77], v27 offset:16384
    ds_read_b64_tr_b16 a[78:79], v27 offset:16896
    ds_write_b128 v46, a[168:171] offset:2048
    v_mfma_f32_16x16x32_bf16 a[132:135], a[200:203], v[100:103], a[132:135]
    v_mfma_f32_16x16x32_bf16 a[136:139], a[204:207], v[96:99], a[136:139]
    ds_write_b128 v46, a[172:175] offset:3072
    v_mfma_f32_16x16x32_bf16 a[140:143], a[204:207], v[100:103], a[140:143]
    s_cmp_lt_u32 s39, 7
    s_cbranch_scc1 L_hasB
    s_mov_b32 s18, 4194304
    s_mov_b32 s22, 3670016
    s_and_b32 s0, s36, 3
    s_lshl_b32 s0, s0, 2
    s_add_u32 s0, s0, s34
    s_lshr_b32 s1, s36, 2
    s_lshr_b32 s3, s1, 1
    s_and_b32 s1, s1, 1
    s_xor_b32 s43, s3, s1
    s_xor_b32 s43, s43, 1
    s_lshl_b32 s3, s3, 4
    s_add_u32 s3, s3, s0
    s_lshl_b32 s3, s3, 3
    s_add_u32 s3, s3, s43
    s_lshl_b32 s73, s3, 14
    s_lshr_b32 s3, s0, 2
    s_lshl_b32 s3, s3, 1
    s_add_u32 s3, s3, s43
    s_lshl_b32 s3, s3, 1
    s_bfe_u32 s74, s0, 0x10001
    s_add_u32 s3, s3, s74
    s_lshl_b32 s3, s3, 1
    s_and_b32 s74, s0, 1
    s_add_u32 s3, s3, s74
    s_mul_i32 s74, s3, 114688
    s_mul_i32 s3, s1, 384
    s_add_u32 s74, s74, s3
    v_lshlrev_b32 v59, 7, v0
    v_lshrrev_b32 v60, 2, v0
    v_mul_u32_u24 v60, 896, v60
    v_and_b32 v61, 3, v0
    v_lshlrev_b32 v61, 7, v61
    v_add_u32 v60, v60, v61
    ds_write_b128 v47, a[176:179] offset:0
    ds_write_b128 v47, a[180:183] offset:1024
    ds_write_b128 v47, a[184:187] offset:2048
    ds_write_b128 v47, a[188:191] offset:3072
    s_waitcnt lgkmcnt(0)
    s_barrier
    ds_read_b128 v[80:83], v50 offset:8192
    ds_read_b128 v[84:87], v50 offset:9216
    ds_read_b128 v[88:91], v50 offset:10240
    ds_read_b128 v[92:95], v50 offset:11264
    ds_read_b128 v[96:99], v50 offset:12288
    ds_read_b128 v[100:103], v50 offset:13312
    ds_read_b128 v[104:107], v50 offset:14336
    ds_read_b128 v[108:111], v50 offset:15360
    ds_read_b128 v[112:115], v48 offset:0
    ds_read_b128 v[116:119], v48 offset:1024
    ds_read_b128 v[120:123], v48 offset:2048
    ds_read_b128 v[124:127], v48 offset:3072
    v_accvgpr_read_b32 v64, a128
    v_accvgpr_read_b32 v65, a129
    v_accvgpr_read_b32 v66, a130
    v_accvgpr_read_b32 v67, a131
    v_accvgpr_read_b32 v68, a132
    v_accvgpr_read_b32 v69, a133
    v_accvgpr_read_b32 v70, a134
    v_accvgpr_read_b32 v71, a135
    v_accvgpr_read_b32 v72, a136
    v_accvgpr_read_b32 v73, a137
    v_accvgpr_read_b32 v74, a138
    v_accvgpr_read_b32 v75, a139
    v_accvgpr_read_b32 v76, a140
    v_accvgpr_read_b32 v77, a141
    v_accvgpr_read_b32 v78, a142
    v_accvgpr_read_b32 v79, a143
    s_waitcnt lgkmcnt(0)
    v_add_f32 v80, v80, v96
    v_add_f32 v81, v81, v97
    v_add_f32 v82, v82, v98
    v_add_f32 v83, v83, v99
    v_add_f32 v84, v84, v100
    v_add_f32 v85, v85, v101
    v_add_f32 v86, v86, v102
    v_add_f32 v87, v87, v103
    v_add_f32 v88, v88, v104
    v_add_f32 v89, v89, v105
    v_add_f32 v90, v90, v106
    v_add_f32 v91, v91, v107
    v_add_f32 v92, v92, v108
    v_add_f32 v93, v93, v109
    v_add_f32 v94, v94, v110
    v_add_f32 v95, v95, v111
    v_add_f32 v64, v64, v112
    v_add_f32 v65, v65, v113
    v_add_f32 v66, v66, v114
    v_add_f32 v67, v67, v115
    v_add_f32 v68, v68, v116
    v_add_f32 v69, v69, v117
    v_add_f32 v70, v70, v118
    v_add_f32 v71, v71, v119
    v_add_f32 v72, v72, v120
    v_add_f32 v73, v73, v121
    v_add_f32 v74, v74, v122
    v_add_f32 v75, v75, v123
    v_add_f32 v76, v76, v124
    v_add_f32 v77, v77, v125
    v_add_f32 v78, v78, v126
    v_add_f32 v79, v79, v127
    v_add_f32 v64, v64, v80
    v_add_f32 v65, v65, v81
    v_add_f32 v66, v66, v82
    v_add_f32 v67, v67, v83
    v_add_f32 v68, v68, v84
    v_add_f32 v69, v69, v85
    v_add_f32 v70, v70, v86
    v_add_f32 v71, v71, v87
    v_add_f32 v72, v72, v88
    v_add_f32 v73, v73, v89
    v_add_f32 v74, v74, v90
    v_add_f32 v75, v75, v91
    v_add_f32 v76, v76, v92
    v_add_f32 v77, v77, v93
    v_add_f32 v78, v78, v94
    v_add_f32 v79, v79, v95
    v_max3_f32 v32, v64, v65, v66
    v_max3_f32 v33, v68, v69, v70
    v_max3_f32 v32, v32, v67, v72
    v_max3_f32 v33, v33, v71, v76
    v_max3_f32 v32, v32, v73, v74
    v_max3_f32 v33, v33, v77, v78
    v_max_f32 v32, v32, v75
    v_max_f32 v33, v33, v79
    v_mov_b32 v34, v32
    v_mov_b32 v35, v33
    s_nop 0
    v_permlane16_swap_b32 v32, v34
    v_permlane16_swap_b32 v33, v35
    v_max_f32 v32, v32, v34
    v_max_f32 v33, v33, v35
    v_mov_b32 v34, v32
    v_mov_b32 v35, v33
    s_nop 0
    v_permlane32_swap_b32 v32, v34
    v_permlane32_swap_b32 v33, v35
    v_max_f32 v32, v32, v34
    v_max_f32 v33, v33, v35
    v_mul_f32 v32, s84, v32
    v_mul_f32 v33, s84, v33
    v_fma_f32 v64, v64, s84, -v32
    v_fma_f32 v68, v68, s84, -v33
    v_fma_f32 v65, v65, s84, -v32
    v_fma_f32 v69, v69, s84, -v33
    v_fma_f32 v66, v66, s84, -v32
    v_fma_f32 v70, v70, s84, -v33
    v_fma_f32 v67, v67, s84, -v32
    v_fma_f32 v71, v71, s84, -v33
    v_fma_f32 v72, v72, s84, -v32
    v_fma_f32 v76, v76, s84, -v33
    v_fma_f32 v73, v73, s84, -v32
    v_fma_f32 v77, v77, s84, -v33
    v_fma_f32 v74, v74, s84, -v32
    v_fma_f32 v78, v78, s84, -v33
    v_fma_f32 v75, v75, s84, -v32
    v_fma_f32 v79, v79, s84, -v33
    v_exp_f32 v64, v64
    v_exp_f32 v68, v68
    v_exp_f32 v65, v65
    v_exp_f32 v69, v69
    v_exp_f32 v66, v66
    v_exp_f32 v70, v70
    v_exp_f32 v67, v67
    v_exp_f32 v71, v71
    v_exp_f32 v72, v72
    v_exp_f32 v76, v76
    v_exp_f32 v73, v73
    v_exp_f32 v77, v77
    v_exp_f32 v74, v74
    v_exp_f32 v78, v78
    v_exp_f32 v75, v75
    v_exp_f32 v79, v79
    v_add_f32 v80, v64, v65
    v_add_f32 v84, v68, v69
    v_add_f32 v81, v66, v67
    v_add_f32 v85, v70, v71
    v_add_f32 v82, v72, v73
    v_add_f32 v86, v76, v77
    v_add_f32 v83, v74, v75
    v_add_f32 v87, v78, v79
    v_add_f32 v80, v80, v81
    v_add_f32 v84, v84, v85
    v_add_f32 v81, v82, v83
    v_add_f32 v85, v86, v87
    v_add_f32 v32, v80, v81
    v_add_f32 v33, v84, v85
    v_mov_b32 v34, v32
    v_mov_b32 v35, v33
    s_nop 0
    v_permlane16_swap_b32 v32, v34
    v_permlane16_swap_b32 v33, v35
    v_add_f32 v32, v32, v34
    v_add_f32 v33, v33, v35
    v_mov_b32 v34, v32
    v_mov_b32 v35, v33
    s_nop 0
    v_permlane32_swap_b32 v32, v34
    v_permlane32_swap_b32 v33, v35
    v_add_f32 v32, v32, v34
    v_add_f32 v33, v33, v35
    v_rcp_f32 v32, v32
    v_rcp_f32 v33, v33
    v_mul_f32 v64, v64, v32
    v_mul_f32 v68, v68, v33
    v_mul_f32 v65, v65, v32
    v_mul_f32 v69, v69, v33
    v_mul_f32 v66, v66, v32
    v_mul_f32 v70, v70, v33
    v_mul_f32 v67, v67, v32
    v_mul_f32 v71, v71, v33
    v_mul_f32 v72, v72, v32
    v_mul_f32 v76, v76, v33
    v_mul_f32 v73, v73, v32
    v_mul_f32 v77, v77, v33
    v_mul_f32 v74, v74, v32
    v_mul_f32 v78, v78, v33
    v_mul_f32 v75, v75, v32
    v_mul_f32 v79, v79, v33
    v_cvt_pk_bf16_f32 v36, v64, v65
    v_cvt_pk_bf16_f32 v37, v66, v67
    v_cvt_pk_bf16_f32 v38, v72, v73
    v_cvt_pk_bf16_f32 v39, v74, v75
    v_cvt_pk_bf16_f32 v40, v68, v69
    v_cvt_pk_bf16_f32 v41, v70, v71
    v_cvt_pk_bf16_f32 v42, v76, v77
    v_cvt_pk_bf16_f32 v43, v78, v79
    buffer_store_dwordx4 v[36:39], v44, s[24:27], s76 offen offset:0 sc1
    buffer_store_dwordx4 v[40:43], v44, s[24:27], s76 offen offset:1024 sc1
    s_waitcnt vmcnt(0)
    s_barrier
    s_cmp_eq_u32 s34, 0
    s_cbranch_scc0 L_sig_a
    v_mov_b32 v54, s82
    v_mov_b32 v55, 1
    s_mov_b64 exec, 1
    global_atomic_add v54, v55, s[32:33]
    s_mov_b64 exec, -1
L_sig_a:
    s_add_u32 s75, s73, 0
    buffer_load_dword v6, v59, s[16:19], s75 offen
    s_add_u32 s75, s73, 8192
    buffer_load_dword v7, v59, s[16:19], s75 offen
    s_add_u32 s75, s73, 32768
    buffer_load_dword v6, v59, s[16:19], s75 offen
    s_add_u32 s75, s73, 40960
    buffer_load_dword v7, v59, s[16:19], s75 offen
    s_add_u32 s75, s73, 65536
    buffer_load_dword v6, v59, s[16:19], s75 offen
    s_add_u32 s75, s73, 73728
    buffer_load_dword v7, v59, s[16:19], s75 offen
    s_add_u32 s75, s73, 98304
    buffer_load_dword v6, v59, s[16:19], s75 offen
    s_add_u32 s75, s73, 106496
    buffer_load_dword v7, v59, s[16:19], s75 offen
    s_add_u32 s75, s74, 0
    buffer_load_dword v4, v60, s[20:23], s75 offen
    s_add_u32 s75, s74, 14336
    buffer_load_dword v5, v60, s[20:23], s75 offen
    s_add_u32 s75, s74, 28672
    buffer_load_dword v4, v60, s[20:23], s75 offen
    s_add_u32 s75, s74, 43008
    buffer_load_dword v5, v60, s[20:23], s75 offen
    s_add_u32 s75, s74, 57344
    buffer_load_dword v4, v60, s[20:23], s75 offen
    s_add_u32 s75, s74, 71680
    buffer_load_dword v5, v60, s[20:23], s75 offen
    s_add_u32 s75, s74, 86016
    buffer_load_dword v4, v60, s[20:23], s75 offen
    s_add_u32 s75, s74, 100352
    buffer_load_dword v5, v60, s[20:23], s75 offen
    s_waitcnt vmcnt(0)
    s_endpgm
L_hasB:
    s_waitcnt lgkmcnt(0)
    v_mfma_f32_16x16x32_bf16 v[128:131], a[0:3], a[48:51], 0
    s_add_u32 m0, s41, 16384
    ds_write_b128 v47, a[176:179] offset:0
    v_mfma_f32_16x16x32_bf16 v[132:135], a[4:7], a[48:51], 0
    s_add_u32 s74, s71, s63
    v_mfma_f32_16x16x32_bf16 v[136:139], a[8:11], a[48:51], 0
    buffer_load_dwordx4 v12, s[16:19], s74 offen lds
    v_mfma_f32_16x16x32_bf16 v[140:143], a[12:15], a[48:51], 0
    s_addk_i32 m0, 0x400
    v_mfma_f32_16x16x32_bf16 v[144:147], a[0:3], a[52:55], 0
    buffer_load_dwordx4 v13, s[16:19], s74 offen lds
    v_mfma_f32_16x16x32_bf16 v[148:151], a[4:7], a[52:55], 0
    s_addk_i32 m0, 0x400
    v_mfma_f32_16x16x32_bf16 v[152:155], a[8:11], a[52:55], 0
    buffer_load_dwordx4 v14, s[16:19], s74 offen lds
    v_mfma_f32_16x16x32_bf16 v[156:159], a[12:15], a[52:55], 0
    s_addk_i32 m0, 0x400
    v_mfma_f32_16x16x32_bf16 v[160:163], a[0:3], a[56:59], 0
    buffer_load_dwordx4 v15, s[16:19], s74 offen lds
    ds_write_b128 v47, a[180:183] offset:1024
    v_mfma_f32_16x16x32_bf16 v[164:167], a[4:7], a[56:59], 0
    s_addk_i32 m0, 0x400
    v_mfma_f32_16x16x32_bf16 v[168:171], a[8:11], a[56:59], 0
    s_add_u32 s88, s72, s67
    v_mfma_f32_16x16x32_bf16 v[172:175], a[12:15], a[56:59], 0
    s_mov_b32 s75, s88
    v_mfma_f32_16x16x32_bf16 v[176:179], a[0:3], a[60:63], 0
    buffer_load_dwordx4 v16, s[20:23], s75 offen lds
    v_mfma_f32_16x16x32_bf16 v[180:183], a[4:7], a[60:63], 0
    s_addk_i32 m0, 0x400
    v_mfma_f32_16x16x32_bf16 v[184:187], a[8:11], a[60:63], 0
    buffer_load_dwordx4 v17, s[20:23], s75 offen lds
    v_mfma_f32_16x16x32_bf16 v[188:191], a[12:15], a[60:63], 0
    s_addk_i32 m0, 0x400
    v_mfma_f32_16x16x32_bf16 v[192:195], a[0:3], a[64:67], 0
    buffer_load_dwordx4 v18, s[20:23], s75 offen lds
    ds_write_b128 v47, a[184:187] offset:2048
    v_mfma_f32_16x16x32_bf16 v[196:199], a[4:7], a[64:67], 0
    s_addk_i32 m0, 0x400
    v_mfma_f32_16x16x32_bf16 v[200:203], a[8:11], a[64:67], 0
    buffer_load_dwordx4 v19, s[20:23], s75 offen lds
    v_mfma_f32_16x16x32_bf16 v[204:207], a[12:15], a[64:67], 0
    s_addk_i32 m0, 0x400
    v_mfma_f32_16x16x32_bf16 v[208:211], a[0:3], a[68:71], 0
    s_add_u32 s75, s88, 229376
    v_mfma_f32_16x16x32_bf16 v[212:215], a[4:7], a[68:71], 0
    buffer_load_dwordx4 v16, s[20:23], s75 offen lds
    v_mfma_f32_16x16x32_bf16 v[216:219], a[8:11], a[68:71], 0
    v_mfma_f32_16x16x32_bf16 v[220:223], a[12:15], a[68:71], 0
    s_waitcnt vmcnt(13)
    ds_read_b64_tr_b16 a[80:81], v20 offset:0
    ds_read_b64_tr_b16 a[82:83], v20 offset:512
    s_addk_i32 m0, 0x400
    v_mfma_f32_16x16x32_bf16 v[224:227], a[0:3], a[72:75], 0
    ds_read_b64_tr_b16 a[84:85], v21 offset:0
    ds_read_b64_tr_b16 a[86:87], v21 offset:512
    ds_read_b64_tr_b16 a[88:89], v22 offset:0
    buffer_load_dwordx4 v17, s[20:23], s75 offen lds
    ds_write_b128 v47, a[188:191] offset:3072
    v_mfma_f32_16x16x32_bf16 v[228:231], a[4:7], a[72:75], 0
    ds_read_b64_tr_b16 a[90:91], v22 offset:512
    ds_read_b64_tr_b16 a[92:93], v23 offset:0
    ds_read_b64_tr_b16 a[94:95], v23 offset:512
    s_addk_i32 m0, 0x400
    v_mfma_f32_16x16x32_bf16 v[232:235], a[8:11], a[72:75], 0
    ds_read_b64_tr_b16 a[96:97], v20 offset:4096
    ds_read_b64_tr_b16 a[98:99], v20 offset:4608
    ds_read_b64_tr_b16 a[100:101], v21 offset:4096
    buffer_load_dwordx4 v18, s[20:23], s75 offen lds
    v_mfma_f32_16x16x32_bf16 v[236:239], a[12:15], a[72:75], 0
    ds_read_b64_tr_b16 a[102:103], v21 offset:4608
    ds_read_b64_tr_b16 a[104:105], v22 offset:4096
    ds_read_b64_tr_b16 a[106:107], v22 offset:4608
    s_addk_i32 m0, 0x400
    v_mfma_f32_16x16x32_bf16 v[240:243], a[0:3], a[76:79], 0
    ds_read_b64_tr_b16 a[108:109], v23 offset:4096
    ds_read_b64_tr_b16 a[110:111], v23 offset:4608
    buffer_load_dwordx4 v19, s[20:23], s75 offen lds
    v_mfma_f32_16x16x32_bf16 v[244:247], a[4:7], a[76:79], 0
    v_mfma_f32_16x16x32_bf16 v[248:251], a[8:11], a[76:79], 0
    v_mfma_f32_16x16x32_bf16 v[252:255], a[12:15], a[76:79], 0
    s_waitcnt lgkmcnt(0)
    v_mfma_f32_16x16x32_bf16 v[128:131], a[16:19], a[80:83], v[128:131]
    s_add_u32 m0, s42, 16384
    v_accvgpr_read_b32 v64, a128
    v_mfma_f32_16x16x32_bf16 v[132:135], a[20:23], a[80:83], v[132:135]
    s_add_u32 s75, s88, 28672
    v_mfma_f32_16x16x32_bf16 v[136:139], a[24:27], a[80:83], v[136:139]
    buffer_load_dwordx4 v16, s[20:23], s75 offen lds
    v_accvgpr_read_b32 v65, a129
    v_mfma_f32_16x16x32_bf16 v[140:143], a[28:31], a[80:83], v[140:143]
    s_addk_i32 m0, 0x400
    v_mfma_f32_16x16x32_bf16 v[144:147], a[16:19], a[84:87], v[144:147]
    buffer_load_dwordx4 v17, s[20:23], s75 offen lds
    v_accvgpr_read_b32 v66, a130
    v_mfma_f32_16x16x32_bf16 v[148:151], a[20:23], a[84:87], v[148:151]
    s_addk_i32 m0, 0x400
    v_mfma_f32_16x16x32_bf16 v[152:155], a[24:27], a[84:87], v[152:155]
    buffer_load_dwordx4 v18, s[20:23], s75 offen lds
    v_accvgpr_read_b32 v67, a131
    v_mfma_f32_16x16x32_bf16 v[156:159], a[28:31], a[84:87], v[156:159]
    s_addk_i32 m0, 0x400
    v_mfma_f32_16x16x32_bf16 v[160:163], a[16:19], a[88:91], v[160:163]
    buffer_load_dwordx4 v19, s[20:23], s75 offen lds
    v_accvgpr_read_b32 v68, a132
    v_mfma_f32_16x16x32_bf16 v[164:167], a[20:23], a[88:91], v[164:167]
    s_add_u32 m0, s41, 0
    v_mfma_f32_16x16x32_bf16 v[168:171], a[24:27], a[88:91], v[168:171]
    s_add_u32 s75, s88, 258048
    v_accvgpr_read_b32 v69, a133
    v_mfma_f32_16x16x32_bf16 v[172:175], a[28:31], a[88:91], v[172:175]
    v_mfma_f32_16x16x32_bf16 v[176:179], a[16:19], a[92:95], v[176:179]
    buffer_load_dwordx4 v16, s[20:23], s75 offen lds
    v_accvgpr_read_b32 v70, a134
    v_mfma_f32_16x16x32_bf16 v[180:183], a[20:23], a[92:95], v[180:183]
    s_addk_i32 m0, 0x400
    v_mfma_f32_16x16x32_bf16 v[184:187], a[24:27], a[92:95], v[184:187]
    buffer_load_dwordx4 v17, s[20:23], s75 offen lds
    v_accvgpr_read_b32 v71, a135
    v_mfma_f32_16x16x32_bf16 v[188:191], a[28:31], a[92:95], v[188:191]
    s_addk_i32 m0, 0x400
    v_mfma_f32_16x16x32_bf16 v[192:195], a[16:19], a[96:99], v[192:195]
    buffer_load_dwordx4 v18, s[20:23], s75 offen lds
    v_accvgpr_read_b32 v72, a136
    v_mfma_f32_16x16x32_bf16 v[196:199], a[20:23], a[96:99], v[196:199]
    s_addk_i32 m0, 0x400
    v_mfma_f32_16x16x32_bf16 v[200:203], a[24:27], a[96:99], v[200:203]
    buffer_load_dwordx4 v19, s[20:23], s75 offen lds
    v_accvgpr_read_b32 v73, a137
    v_mfma_f32_16x16x32_bf16 v[204:207], a[28:31], a[96:99], v[204:207]
    s_addk_i32 m0, 0x400
    v_mfma_f32_16x16x32_bf16 v[208:211], a[16:19], a[100:103], v[208:211]
    s_add_u32 s74, s70, s64
    v_accvgpr_read_b32 v74, a138
    v_mfma_f32_16x16x32_bf16 v[212:215], a[20:23], a[100:103], v[212:215]
    buffer_load_dwordx4 v12, s[16:19], s74 offen lds
    v_mfma_f32_16x16x32_bf16 v[216:219], a[24:27], a[100:103], v[216:219]
    v_accvgpr_read_b32 v75, a139
    v_mfma_f32_16x16x32_bf16 v[220:223], a[28:31], a[100:103], v[220:223]
    s_barrier
    s_waitcnt vmcnt(9)
    ds_read_b128 a[32:35], v30 offset:32768
    ds_read_b128 a[36:39], v30 offset:34816
    ds_read_b128 a[40:43], v28 offset:16384
    ds_read_b128 a[44:47], v28 offset:18432
    ds_read_b64_tr_b16 a[48:49], v20 offset:20480
    s_addk_i32 m0, 0x400
    v_mfma_f32_16x16x32_bf16 v[224:227], a[16:19], a[104:107], v[224:227]
    ds_read_b64_tr_b16 a[50:51], v20 offset:20992
    ds_read_b64_tr_b16 a[52:53], v21 offset:20480
    ds_read_b64_tr_b16 a[54:55], v21 offset:20992
    ds_read_b64_tr_b16 a[56:57], v22 offset:20480
    ds_read_b64_tr_b16 a[58:59], v22 offset:20992
    ds_read_b64_tr_b16 a[60:61], v23 offset:20480
    buffer_load_dwordx4 v13, s[16:19], s74 offen lds
    v_accvgpr_read_b32 v76, a140
    v_mfma_f32_16x16x32_bf16 v[228:231], a[20:23], a[104:107], v[228:231]
    ds_read_b64_tr_b16 a[62:63], v23 offset:20992
    ds_read_b64_tr_b16 a[64:65], v20 offset:24576
    ds_read_b64_tr_b16 a[66:67], v20 offset:25088
    ds_read_b64_tr_b16 a[68:69], v21 offset:24576
    ds_read_b64_tr_b16 a[70:71], v21 offset:25088
    ds_read_b64_tr_b16 a[72:73], v22 offset:24576
    s_addk_i32 m0, 0x400
    v_mfma_f32_16x16x32_bf16 v[232:235], a[24:27], a[104:107], v[232:235]
    ds_read_b64_tr_b16 a[74:75], v22 offset:25088
    ds_read_b64_tr_b16 a[76:77], v23 offset:24576
    ds_read_b64_tr_b16 a[78:79], v23 offset:25088
    ds_read_b128 a[0:3], v31 offset:32768
    ds_read_b128 a[4:7], v31 offset:34816
    ds_read_b128 a[8:11], v29 offset:16384
    ds_read_b128 a[12:15], v29 offset:18432
    buffer_load_dwordx4 v14, s[16:19], s74 offen lds
    v_accvgpr_read_b32 v77, a141
    v_mfma_f32_16x16x32_bf16 v[236:239], a[28:31], a[104:107], v[236:239]
    ds_read_b128 v[80:83], v50 offset:8192
    ds_read_b128 v[84:87], v50 offset:9216
    ds_read_b128 v[88:91], v50 offset:10240
    ds_read_b128 v[92:95], v50 offset:11264
    ds_read_b128 v[96:99], v50 offset:12288
    ds_read_b128 v[100:103], v50 offset:13312
    s_addk_i32 m0, 0x400
    v_mfma_f32_16x16x32_bf16 v[240:243], a[16:19], a[108:111], v[240:243]
    ds_read_b128 v[104:107], v50 offset:14336
    ds_read_b128 v[108:111], v50 offset:15360
    ds_read_b128 v[112:115], v48 offset:0
    ds_read_b128 v[116:119], v48 offset:1024
    ds_read_b128 v[120:123], v48 offset:2048
    ds_read_b128 v[124:127], v48 offset:3072
    buffer_load_dwordx4 v15, s[16:19], s74 offen lds
    v_accvgpr_read_b32 v78, a142
    v_mfma_f32_16x16x32_bf16 v[244:247], a[20:23], a[108:111], v[244:247]
    v_mfma_f32_16x16x32_bf16 v[248:251], a[24:27], a[108:111], v[248:251]
    v_accvgpr_read_b32 v79, a143
    v_mfma_f32_16x16x32_bf16 v[252:255], a[28:31], a[108:111], v[252:255]
    s_waitcnt lgkmcnt(0)
    v_mfma_f32_16x16x32_bf16 v[128:131], a[32:35], a[48:51], v[128:131]
    s_add_u32 m0, s42, 32768
    v_add_f32 v80, v80, v96
    v_add_f32 v81, v81, v97
    v_add_f32 v82, v82, v98
    v_mfma_f32_16x16x32_bf16 v[132:135], a[36:39], a[48:51], v[132:135]
    s_add_u32 s74, s71, s64
    v_add_f32 v83, v83, v99
    v_add_f32 v84, v84, v100
    v_mfma_f32_16x16x32_bf16 v[136:139], a[40:43], a[48:51], v[136:139]
    buffer_load_dwordx4 v12, s[16:19], s74 offen lds
    v_add_f32 v85, v85, v101
    v_add_f32 v86, v86, v102
    v_add_f32 v87, v87, v103
    v_mfma_f32_16x16x32_bf16 v[140:143], a[44:47], a[48:51], v[140:143]
    s_addk_i32 m0, 0x400
    v_add_f32 v88, v88, v104
    v_add_f32 v89, v89, v105
    v_mfma_f32_16x16x32_bf16 v[144:147], a[32:35], a[52:55], v[144:147]
    buffer_load_dwordx4 v13, s[16:19], s74 offen lds
    v_add_f32 v90, v90, v106
    v_add_f32 v91, v91, v107
    v_add_f32 v92, v92, v108
    v_mfma_f32_16x16x32_bf16 v[148:151], a[36:39], a[52:55], v[148:151]
    s_addk_i32 m0, 0x400
    v_add_f32 v93, v93, v109
    v_add_f32 v94, v94, v110
    v_mfma_f32_16x16x32_bf16 v[152:155], a[40:43], a[52:55], v[152:155]
    buffer_load_dwordx4 v14, s[16:19], s74 offen lds
    v_add_f32 v95, v95, v111
    v_add_f32 v64, v64, v112
    v_mfma_f32_16x16x32_bf16 v[156:159], a[44:47], a[52:55], v[156:159]
    s_addk_i32 m0, 0x400
    v_add_f32 v65, v65, v113
    v_add_f32 v66, v66, v114
    v_add_f32 v67, v67, v115
    v_mfma_f32_16x16x32_bf16 v[160:163], a[32:35], a[56:59], v[160:163]
    buffer_load_dwordx4 v15, s[16:19], s74 offen lds
    v_add_f32 v68, v68, v116
    v_add_f32 v69, v69, v117
    v_mfma_f32_16x16x32_bf16 v[164:167], a[36:39], a[56:59], v[164:167]
    s_add_u32 m0, s41, 16384
    v_add_f32 v70, v70, v118
    v_add_f32 v71, v71, v119
    v_add_f32 v72, v72, v120
    v_mfma_f32_16x16x32_bf16 v[168:171], a[40:43], a[56:59], v[168:171]
    s_add_u32 s88, s72, s68
    v_add_f32 v73, v73, v121
    v_add_f32 v74, v74, v122
    v_mfma_f32_16x16x32_bf16 v[172:175], a[44:47], a[56:59], v[172:175]
    s_mov_b32 s75, s88
    v_add_f32 v75, v75, v123
    v_add_f32 v76, v76, v124
    v_mfma_f32_16x16x32_bf16 v[176:179], a[32:35], a[60:63], v[176:179]
    buffer_load_dwordx4 v16, s[20:23], s75 offen lds
    v_add_f32 v77, v77, v125
    v_add_f32 v78, v78, v126
    v_add_f32 v79, v79, v127
    v_mfma_f32_16x16x32_bf16 v[180:183], a[36:39], a[60:63], v[180:183]
    s_addk_i32 m0, 0x400
    v_add_f32 v64, v64, v80
    v_add_f32 v65, v65, v81
    v_mfma_f32_16x16x32_bf16 v[184:187], a[40:43], a[60:63], v[184:187]
    buffer_load_dwordx4 v17, s[20:23], s75 offen lds
    v_add_f32 v66, v66, v82
    v_add_f32 v67, v67, v83
    v_add_f32 v68, v68, v84
    v_mfma_f32_16x16x32_bf16 v[188:191], a[44:47], a[60:63], v[188:191]
    s_addk_i32 m0, 0x400
    v_add_f32 v69, v69, v85
    v_add_f32 v70, v70, v86
    v_mfma_f32_16x16x32_bf16 v[192:195], a[32:35], a[64:67], v[192:195]
    buffer_load_dwordx4 v18, s[20:23], s75 offen lds
    v_add_f32 v71, v71, v87
    v_add_f32 v72, v72, v88
    v_mfma_f32_16x16x32_bf16 v[196:199], a[36:39], a[64:67], v[196:199]
    s_addk_i32 m0, 0x400
    v_add_f32 v73, v73, v89
    v_add_f32 v74, v74, v90
    v_add_f32 v75, v75, v91
    v_mfma_f32_16x16x32_bf16 v[200:203], a[40:43], a[64:67], v[200:203]
    buffer_load_dwordx4 v19, s[20:23], s75 offen lds
    v_add_f32 v76, v76, v92
    v_add_f32 v77, v77, v93
    v_mfma_f32_16x16x32_bf16 v[204:207], a[44:47], a[64:67], v[204:207]
    s_addk_i32 m0, 0x400
    v_add_f32 v78, v78, v94
    v_add_f32 v79, v79, v95
    v_max3_f32 v32, v64, v65, v66
    v_mfma_f32_16x16x32_bf16 v[208:211], a[32:35], a[68:71], v[208:211]
    s_add_u32 s75, s88, 229376
    v_max3_f32 v33, v68, v69, v70
    v_max3_f32 v32, v32, v67, v72
    v_mfma_f32_16x16x32_bf16 v[212:215], a[36:39], a[68:71], v[212:215]
    buffer_load_dwordx4 v16, s[20:23], s75 offen lds
    v_max3_f32 v33, v33, v71, v76
    v_max3_f32 v32, v32, v73, v74
    v_mfma_f32_16x16x32_bf16 v[216:219], a[40:43], a[68:71], v[216:219]
    v_max3_f32 v33, v33, v77, v78
    v_max_f32 v32, v32, v75
    v_max_f32 v33, v33, v79
    v_mfma_f32_16x16x32_bf16 v[220:223], a[44:47], a[68:71], v[220:223]
    s_waitcnt vmcnt(13)
    ds_read_b64_tr_b16 a[80:81], v24 offset:16384
    ds_read_b64_tr_b16 a[82:83], v24 offset:16896
    s_addk_i32 m0, 0x400
    v_mov_b32 v34, v32
    v_mov_b32 v35, v33
    v_mfma_f32_16x16x32_bf16 v[224:227], a[32:35], a[72:75], v[224:227]
    ds_read_b64_tr_b16 a[84:85], v25 offset:16384
    ds_read_b64_tr_b16 a[86:87], v25 offset:16896
    ds_read_b64_tr_b16 a[88:89], v26 offset:16384
    buffer_load_dwordx4 v17, s[20:23], s75 offen lds
    v_permlane16_swap_b32 v32, v34
    v_permlane16_swap_b32 v33, v35
    v_max_f32 v32, v32, v34
    v_mfma_f32_16x16x32_bf16 v[228:231], a[36:39], a[72:75], v[228:231]
    ds_read_b64_tr_b16 a[90:91], v26 offset:16896
    ds_read_b64_tr_b16 a[92:93], v27 offset:16384
    ds_read_b64_tr_b16 a[94:95], v27 offset:16896
    s_addk_i32 m0, 0x400
    v_max_f32 v33, v33, v35
    v_mov_b32 v34, v32
    v_mfma_f32_16x16x32_bf16 v[232:235], a[40:43], a[72:75], v[232:235]
    ds_read_b64_tr_b16 a[96:97], v20 offset:0
    ds_read_b64_tr_b16 a[98:99], v20 offset:512
    ds_read_b64_tr_b16 a[100:101], v21 offset:0
    buffer_load_dwordx4 v18, s[20:23], s75 offen lds
    v_mov_b32 v35, v33
    v_permlane32_swap_b32 v32, v34
    v_mfma_f32_16x16x32_bf16 v[236:239], a[44:47], a[72:75], v[236:239]
    ds_read_b64_tr_b16 a[102:103], v21 offset:512
    ds_read_b64_tr_b16 a[104:105], v22 offset:0
    ds_read_b64_tr_b16 a[106:107], v22 offset:512
    s_addk_i32 m0, 0x400
    v_permlane32_swap_b32 v33, v35
    v_max_f32 v32, v32, v34
    v_max_f32 v33, v33, v35
    v_mfma_f32_16x16x32_bf16 v[240:243], a[32:35], a[76:79], v[240:243]
    ds_read_b64_tr_b16 a[108:109], v23 offset:0
    ds_read_b64_tr_b16 a[110:111], v23 offset:512
    buffer_load_dwordx4 v19, s[20:23], s75 offen lds
    v_mul_f32 v32, s84, v32
    v_mul_f32 v33, s84, v33
    v_mfma_f32_16x16x32_bf16 v[244:247], a[36:39], a[76:79], v[244:247]
    v_fma_f32 v64, v64, s84, -v32
    v_fma_f32 v68, v68, s84, -v33
    v_fma_f32 v65, v65, s84, -v32
    v_mfma_f32_16x16x32_bf16 v[248:251], a[40:43], a[76:79], v[248:251]
    v_fma_f32 v69, v69, s84, -v33
    v_fma_f32 v66, v66, s84, -v32
    v_mfma_f32_16x16x32_bf16 v[252:255], a[44:47], a[76:79], v[252:255]
    v_fma_f32 v70, v70, s84, -v33
    v_fma_f32 v67, v67, s84, -v32
    s_waitcnt lgkmcnt(0)
    v_mfma_f32_16x16x32_bf16 v[128:131], a[0:3], a[80:83], v[128:131]
    s_addk_i32 m0, 0x400
    v_fma_f32 v71, v71, s84, -v33
    v_fma_f32 v72, v72, s84, -v32
    v_fma_f32 v76, v76, s84, -v33
    v_mfma_f32_16x16x32_bf16 v[132:135], a[4:7], a[80:83], v[132:135]
    s_add_u32 s75, s88, 28672
    v_fma_f32 v73, v73, s84, -v32
    v_fma_f32 v77, v77, s84, -v33
    v_mfma_f32_16x16x32_bf16 v[136:139], a[8:11], a[80:83], v[136:139]
    buffer_load_dwordx4 v16, s[20:23], s75 offen lds
    v_fma_f32 v74, v74, s84, -v32
    v_fma_f32 v78, v78, s84, -v33
    v_fma_f32 v75, v75, s84, -v32
    v_mfma_f32_16x16x32_bf16 v[140:143], a[12:15], a[80:83], v[140:143]
    s_addk_i32 m0, 0x400
    v_fma_f32 v79, v79, s84, -v33
    v_exp_f32 v64, v64
    v_mfma_f32_16x16x32_bf16 v[144:147], a[0:3], a[84:87], v[144:147]
    buffer_load_dwordx4 v17, s[20:23], s75 offen lds
    v_exp_f32 v68, v68
    v_exp_f32 v65, v65
    v_exp_f32 v69, v69
    v_mfma_f32_16x16x32_bf16 v[148:151], a[4:7], a[84:87], v[148:151]
    s_addk_i32 m0, 0x400
    v_exp_f32 v66, v66
    v_exp_f32 v70, v70
    v_mfma_f32_16x16x32_bf16 v[152:155], a[8:11], a[84:87], v[152:155]
    buffer_load_dwordx4 v18, s[20:23], s75 offen lds
    v_exp_f32 v67, v67
    v_exp_f32 v71, v71
    v_mfma_f32_16x16x32_bf16 v[156:159], a[12:15], a[84:87], v[156:159]
    s_addk_i32 m0, 0x400
    v_exp_f32 v72, v72
    v_exp_f32 v76, v76
    v_exp_f32 v73, v73
    v_mfma_f32_16x16x32_bf16 v[160:163], a[0:3], a[88:91], v[160:163]
    buffer_load_dwordx4 v19, s[20:23], s75 offen lds
    v_exp_f32 v77, v77
    v_exp_f32 v74, v74
    v_mfma_f32_16x16x32_bf16 v[164:167], a[4:7], a[88:91], v[164:167]
    s_add_u32 m0, s41, 8192
    v_exp_f32 v78, v78
    v_exp_f32 v75, v75
    v_exp_f32 v79, v79
    v_mfma_f32_16x16x32_bf16 v[168:171], a[8:11], a[88:91], v[168:171]
    s_add_u32 s75, s88, 258048
    v_add_f32 v80, v64, v65
    v_add_f32 v84, v68, v69
    v_mfma_f32_16x16x32_bf16 v[172:175], a[12:15], a[88:91], v[172:175]
    v_add_f32 v81, v66, v67
    v_add_f32 v85, v70, v71
    v_mfma_f32_16x16x32_bf16 v[176:179], a[0:3], a[92:95], v[176:179]
    buffer_load_dwordx4 v16, s[20:23], s75 offen lds
    v_add_f32 v82, v72, v73
    v_add_f32 v86, v76, v77
    v_add_f32 v83, v74, v75
    v_mfma_f32_16x16x32_bf16 v[180:183], a[4:7], a[92:95], v[180:183]
    s_addk_i32 m0, 0x400
    v_add_f32 v87, v78, v79
    v_add_f32 v80, v80, v81
    v_mfma_f32_16x16x32_bf16 v[184:187], a[8:11], a[92:95], v[184:187]
    buffer_load_dwordx4 v17, s[20:23], s75 offen lds
    v_add_f32 v84, v84, v85
    v_add_f32 v81, v82, v83
    v_add_f32 v85, v86, v87
    v_mfma_f32_16x16x32_bf16 v[188:191], a[12:15], a[92:95], v[188:191]
    s_addk_i32 m0, 0x400
    v_add_f32 v32, v80, v81
    v_add_f32 v33, v84, v85
    v_mfma_f32_16x16x32_bf16 v[192:195], a[0:3], a[96:99], v[192:195]
    buffer_load_dwordx4 v18, s[20:23], s75 offen lds
    v_mov_b32 v34, v32
    v_mov_b32 v35, v33
    v_mfma_f32_16x16x32_bf16 v[196:199], a[4:7], a[96:99], v[196:199]
    s_addk_i32 m0, 0x400
    v_permlane16_swap_b32 v32, v34
    v_permlane16_swap_b32 v33, v35
    v_add_f32 v32, v32, v34
    v_mfma_f32_16x16x32_bf16 v[200:203], a[8:11], a[96:99], v[200:203]
    buffer_load_dwordx4 v19, s[20:23], s75 offen lds
    v_add_f32 v33, v33, v35
    v_mov_b32 v34, v32
    v_mfma_f32_16x16x32_bf16 v[204:207], a[12:15], a[96:99], v[204:207]
    s_addk_i32 m0, 0x400
    v_mov_b32 v35, v33
    v_permlane32_swap_b32 v32, v34
    s_nop 0
    v_permlane32_swap_b32 v33, v35
    v_mfma_f32_16x16x32_bf16 v[208:211], a[0:3], a[100:103], v[208:211]
    s_add_u32 s74, s70, s65
    v_add_f32 v32, v32, v34
    v_add_f32 v33, v33, v35
    v_mfma_f32_16x16x32_bf16 v[212:215], a[4:7], a[100:103], v[212:215]
    buffer_load_dwordx4 v12, s[16:19], s74 offen lds
    v_rcp_f32 v32, v32
    v_rcp_f32 v33, v33
    v_mfma_f32_16x16x32_bf16 v[216:219], a[8:11], a[100:103], v[216:219]
    v_mul_f32 v64, v64, v32
    v_mul_f32 v68, v68, v33
    v_mul_f32 v65, v65, v32
    v_mfma_f32_16x16x32_bf16 v[220:223], a[12:15], a[100:103], v[220:223]
    s_waitcnt vmcnt(9)
    ds_read_b128 a[16:19], v28 offset:4096
    ds_read_b128 a[20:23], v28 offset:6144
    ds_read_b128 a[24:27], v30 offset:32768
    ds_read_b128 a[28:31], v30 offset:34816
    s_addk_i32 m0, 0x400
    v_mul_f32 v69, v69, v33
    v_mul_f32 v66, v66, v32
    v_mfma_f32_16x16x32_bf16 v[224:227], a[0:3], a[104:107], v[224:227]
    ds_read_b64_tr_b16 a[48:49], v20 offset:16384
    ds_read_b64_tr_b16 a[50:51], v20 offset:16896
    ds_read_b64_tr_b16 a[52:53], v21 offset:16384
    ds_read_b64_tr_b16 a[54:55], v21 offset:16896
    buffer_load_dwordx4 v13, s[16:19], s74 offen lds
    v_mul_f32 v70, v70, v33
    v_mul_f32 v67, v67, v32
    v_mul_f32 v71, v71, v33
    v_mfma_f32_16x16x32_bf16 v[228:231], a[4:7], a[104:107], v[228:231]
    ds_read_b64_tr_b16 a[56:57], v22 offset:16384
    ds_read_b64_tr_b16 a[58:59], v22 offset:16896
    ds_read_b64_tr_b16 a[60:61], v23 offset:16384
    ds_read_b64_tr_b16 a[62:63], v23 offset:16896
    s_addk_i32 m0, 0x400
    v_mul_f32 v72, v72, v32
    v_mul_f32 v76, v76, v33
    v_mfma_f32_16x16x32_bf16 v[232:235], a[8:11], a[104:107], v[232:235]
    ds_read_b64_tr_b16 a[64:65], v20 offset:20480
    ds_read_b64_tr_b16 a[66:67], v20 offset:20992
    ds_read_b64_tr_b16 a[68:69], v21 offset:20480
    ds_read_b64_tr_b16 a[70:71], v21 offset:20992
    buffer_load_dwordx4 v14, s[16:19], s74 offen lds
    v_mul_f32 v73, v73, v32
    v_mul_f32 v77, v77, v33
    v_mfma_f32_16x16x32_bf16 v[236:239], a[12:15], a[104:107], v[236:239]
    ds_read_b64_tr_b16 a[72:73], v22 offset:20480
    ds_read_b64_tr_b16 a[74:75], v22 offset:20992
    ds_read_b64_tr_b16 a[76:77], v23 offset:20480
    ds_read_b64_tr_b16 a[78:79], v23 offset:20992
    s_addk_i32 m0, 0x400
    v_mul_f32 v74, v74, v32
    v_mul_f32 v78, v78, v33
    v_mul_f32 v75, v75, v32
    v_mfma_f32_16x16x32_bf16 v[240:243], a[0:3], a[108:111], v[240:243]
    ds_read_b128 a[32:35], v29 offset:4096
    ds_read_b128 a[36:39], v29 offset:6144
    ds_read_b128 a[40:43], v31 offset:32768
    ds_read_b128 a[44:47], v31 offset:34816
    buffer_load_dwordx4 v15, s[16:19], s74 offen lds
    v_mul_f32 v79, v79, v33
    v_cvt_pk_bf16_f32 v36, v64, v65
    v_mfma_f32_16x16x32_bf16 v[244:247], a[4:7], a[108:111], v[244:247]
    v_cvt_pk_bf16_f32 v37, v66, v67
    v_cvt_pk_bf16_f32 v38, v72, v73
    v_cvt_pk_bf16_f32 v39, v74, v75
    v_mfma_f32_16x16x32_bf16 v[248:251], a[8:11], a[108:111], v[248:251]
    v_cvt_pk_bf16_f32 v40, v68, v69
    v_cvt_pk_bf16_f32 v41, v70, v71
    v_mfma_f32_16x16x32_bf16 v[252:255], a[12:15], a[108:111], v[252:255]
    v_cvt_pk_bf16_f32 v42, v76, v77
    v_cvt_pk_bf16_f32 v43, v78, v79
    buffer_store_dwordx4 v[36:39], v44, s[24:27], s76 offen offset:0 sc1
    buffer_store_dwordx4 v[40:43], v44, s[24:27], s76 offen offset:1024 sc1
    s_waitcnt lgkmcnt(0)
    v_mfma_f32_16x16x32_bf16 v[128:131], a[16:19], a[48:51], v[128:131]
    s_add_u32 m0, s42, 0
    v_mfma_f32_16x16x32_bf16 v[132:135], a[20:23], a[48:51], v[132:135]
    s_add_u32 s74, s71, s65
    v_mfma_f32_16x16x32_bf16 v[136:139], a[24:27], a[48:51], v[136:139]
    buffer_load_dwordx4 v12, s[16:19], s74 offen lds
    v_mfma_f32_16x16x32_bf16 v[140:143], a[28:31], a[48:51], v[140:143]
    s_addk_i32 m0, 0x400
    v_mfma_f32_16x16x32_bf16 v[144:147], a[16:19], a[52:55], v[144:147]
    buffer_load_dwordx4 v13, s[16:19], s74 offen lds
    v_mfma_f32_16x16x32_bf16 v[148:151], a[20:23], a[52:55], v[148:151]
    s_addk_i32 m0, 0x400
    v_mfma_f32_16x16x32_bf16 v[152:155], a[24:27], a[52:55], v[152:155]
    buffer_load_dwordx4 v14, s[16:19], s74 offen lds
    v_mfma_f32_16x16x32_bf16 v[156:159], a[28:31], a[52:55], v[156:159]
    s_addk_i32 m0, 0x400
    v_mfma_f32_16x16x32_bf16 v[160:163], a[16:19], a[56:59], v[160:163]
    buffer_load_dwordx4 v15, s[16:19], s74 offen lds
    v_mfma_f32_16x16x32_bf16 v[164:167], a[20:23], a[56:59], v[164:167]
    s_add_u32 m0, s42, 16384
    v_mfma_f32_16x16x32_bf16 v[168:171], a[24:27], a[56:59], v[168:171]
    s_add_u32 s88, s72, s69
    v_mfma_f32_16x16x32_bf16 v[172:175], a[28:31], a[56:59], v[172:175]
    s_mov_b32 s75, s88
    v_mfma_f32_16x16x32_bf16 v[176:179], a[16:19], a[60:63], v[176:179]
    buffer_load_dwordx4 v16, s[20:23], s75 offen lds
    v_mfma_f32_16x16x32_bf16 v[180:183], a[20:23], a[60:63], v[180:183]
    s_addk_i32 m0, 0x400
    v_mfma_f32_16x16x32_bf16 v[184:187], a[24:27], a[60:63], v[184:187]
    buffer_load_dwordx4 v17, s[20:23], s75 offen lds
    v_mfma_f32_16x16x32_bf16 v[188:191], a[28:31], a[60:63], v[188:191]
    s_addk_i32 m0, 0x400
    v_mfma_f32_16x16x32_bf16 v[192:195], a[16:19], a[64:67], v[192:195]
    buffer_load_dwordx4 v18, s[20:23], s75 offen lds
    v_mfma_f32_16x16x32_bf16 v[196:199], a[20:23], a[64:67], v[196:199]
    s_addk_i32 m0, 0x400
    v_mfma_f32_16x16x32_bf16 v[200:203], a[24:27], a[64:67], v[200:203]
    buffer_load_dwordx4 v19, s[20:23], s75 offen lds
    v_mfma_f32_16x16x32_bf16 v[204:207], a[28:31], a[64:67], v[204:207]
    s_add_u32 m0, s41, 0
    v_mfma_f32_16x16x32_bf16 v[208:211], a[16:19], a[68:71], v[208:211]
    s_add_u32 s75, s88, 229376
    v_mfma_f32_16x16x32_bf16 v[212:215], a[20:23], a[68:71], v[212:215]
    buffer_load_dwordx4 v16, s[20:23], s75 offen lds
    v_mfma_f32_16x16x32_bf16 v[216:219], a[24:27], a[68:71], v[216:219]
    v_mfma_f32_16x16x32_bf16 v[220:223], a[28:31], a[68:71], v[220:223]
    s_waitcnt vmcnt(15)
    ds_read_b64_tr_b16 a[80:81], v20 offset:24576
    ds_read_b64_tr_b16 a[82:83], v20 offset:25088
    s_addk_i32 m0, 0x400
    v_mfma_f32_16x16x32_bf16 v[224:227], a[16:19], a[72:75], v[224:227]
    ds_read_b64_tr_b16 a[84:85], v21 offset:24576
    ds_read_b64_tr_b16 a[86:87], v21 offset:25088
    ds_read_b64_tr_b16 a[88:89], v22 offset:24576
    buffer_load_dwordx4 v17, s[20:23], s75 offen lds
    v_mfma_f32_16x16x32_bf16 v[228:231], a[20:23], a[72:75], v[228:231]
    ds_read_b64_tr_b16 a[90:91], v22 offset:25088
    ds_read_b64_tr_b16 a[92:93], v23 offset:24576
    ds_read_b64_tr_b16 a[94:95], v23 offset:25088
    s_addk_i32 m0, 0x400
    v_mfma_f32_16x16x32_bf16 v[232:235], a[24:27], a[72:75], v[232:235]
    ds_read_b64_tr_b16 a[96:97], v20 offset:8192
    ds_read_b64_tr_b16 a[98:99], v20 offset:8704
    ds_read_b64_tr_b16 a[100:101], v21 offset:8192
    buffer_load_dwordx4 v18, s[20:23], s75 offen lds
    v_mfma_f32_16x16x32_bf16 v[236:239], a[28:31], a[72:75], v[236:239]
    ds_read_b64_tr_b16 a[102:103], v21 offset:8704
    ds_read_b64_tr_b16 a[104:105], v22 offset:8192
    ds_read_b64_tr_b16 a[106:107], v22 offset:8704
    s_addk_i32 m0, 0x400
    v_mfma_f32_16x16x32_bf16 v[240:243], a[16:19], a[76:79], v[240:243]
    ds_read_b64_tr_b16 a[108:109], v23 offset:8192
    ds_read_b64_tr_b16 a[110:111], v23 offset:8704
    buffer_load_dwordx4 v19, s[20:23], s75 offen lds
    v_mfma_f32_16x16x32_bf16 v[244:247], a[20:23], a[76:79], v[244:247]
    v_mfma_f32_16x16x32_bf16 v[248:251], a[24:27], a[76:79], v[248:251]
    v_mfma_f32_16x16x32_bf16 v[252:255], a[28:31], a[76:79], v[252:255]
    s_waitcnt lgkmcnt(0)
    s_waitcnt vmcnt(12)
    s_barrier
    s_cmp_eq_u32 s34, 0
    s_cbranch_scc0 L_sig_b
    v_mov_b32 v54, s82
    v_mov_b32 v55, 1
    s_mov_b64 exec, 1
    global_atomic_add v54, v55, s[32:33]
    s_mov_b64 exec, -1
L_sig_b:
    v_mfma_f32_16x16x32_bf16 v[128:131], a[32:35], a[80:83], v[128:131]
    s_addk_i32 m0, 0x400
    v_mfma_f32_16x16x32_bf16 v[132:135], a[36:39], a[80:83], v[132:135]
    s_add_u32 s75, s88, 28672
    v_mfma_f32_16x16x32_bf16 v[136:139], a[40:43], a[80:83], v[136:139]
    buffer_load_dwordx4 v16, s[20:23], s75 offen lds
    v_mfma_f32_16x16x32_bf16 v[140:143], a[44:47], a[80:83], v[140:143]
    s_addk_i32 m0, 0x400
    v_mfma_f32_16x16x32_bf16 v[144:147], a[32:35], a[84:87], v[144:147]
    buffer_load_dwordx4 v17, s[20:23], s75 offen lds
    v_mfma_f32_16x16x32_bf16 v[148:151], a[36:39], a[84:87], v[148:151]
    s_addk_i32 m0, 0x400
    v_mfma_f32_16x16x32_bf16 v[152:155], a[40:43], a[84:87], v[152:155]
    buffer_load_dwordx4 v18, s[20:23], s75 offen lds
    v_mfma_f32_16x16x32_bf16 v[156:159], a[44:47], a[84:87], v[156:159]
    s_addk_i32 m0, 0x400
    v_mfma_f32_16x16x32_bf16 v[160:163], a[32:35], a[88:91], v[160:163]
    buffer_load_dwordx4 v19, s[20:23], s75 offen lds
    v_mfma_f32_16x16x32_bf16 v[164:167], a[36:39], a[88:91], v[164:167]
    s_add_u32 m0, s42, 32768
    v_mfma_f32_16x16x32_bf16 v[168:171], a[40:43], a[88:91], v[168:171]
    s_add_u32 s75, s88, 258048
    v_mfma_f32_16x16x32_bf16 v[172:175], a[44:47], a[88:91], v[172:175]
    v_mfma_f32_16x16x32_bf16 v[176:179], a[32:35], a[92:95], v[176:179]
    buffer_load_dwordx4 v16, s[20:23], s75 offen lds
    v_mfma_f32_16x16x32_bf16 v[180:183], a[36:39], a[92:95], v[180:183]
    s_addk_i32 m0, 0x400
    v_mfma_f32_16x16x32_bf16 v[184:187], a[40:43], a[92:95], v[184:187]
    buffer_load_dwordx4 v17, s[20:23], s75 offen lds
    v_mfma_f32_16x16x32_bf16 v[188:191], a[44:47], a[92:95], v[188:191]
    s_addk_i32 m0, 0x400
    v_mfma_f32_16x16x32_bf16 v[192:195], a[32:35], a[96:99], v[192:195]
    buffer_load_dwordx4 v18, s[20:23], s75 offen lds
    v_mfma_f32_16x16x32_bf16 v[196:199], a[36:39], a[96:99], v[196:199]
    s_addk_i32 m0, 0x400
    v_mfma_f32_16x16x32_bf16 v[200:203], a[40:43], a[96:99], v[200:203]
    buffer_load_dwordx4 v19, s[20:23], s75 offen lds
    v_mfma_f32_16x16x32_bf16 v[204:207], a[44:47], a[96:99], v[204:207]
    s_add_u32 m0, s41, 16384
    v_mfma_f32_16x16x32_bf16 v[208:211], a[32:35], a[100:103], v[208:211]
    s_add_u32 s74, s85, s62
    v_mfma_f32_16x16x32_bf16 v[212:215], a[36:39], a[100:103], v[212:215]
    buffer_load_dwordx4 v12, s[16:19], s74 offen lds
    v_mfma_f32_16x16x32_bf16 v[216:219], a[40:43], a[100:103], v[216:219]
    v_mfma_f32_16x16x32_bf16 v[220:223], a[44:47], a[100:103], v[220:223]
    s_waitcnt vmcnt(9)
    ds_read_b128 a[0:3], v28 offset:12288
    ds_read_b128 a[4:7], v28 offset:14336
    ds_read_b128 a[8:11], v30 offset:0
    ds_read_b128 a[12:15], v30 offset:2048
    s_addk_i32 m0, 0x400
    v_mfma_f32_16x16x32_bf16 v[224:227], a[32:35], a[104:107], v[224:227]
    ds_read_b64_tr_b16 a[48:49], v24 offset:16384
    ds_read_b64_tr_b16 a[50:51], v24 offset:16896
    ds_read_b64_tr_b16 a[52:53], v25 offset:16384
    ds_read_b64_tr_b16 a[54:55], v25 offset:16896
    buffer_load_dwordx4 v13, s[16:19], s74 offen lds
    v_mfma_f32_16x16x32_bf16 v[228:231], a[36:39], a[104:107], v[228:231]
    ds_read_b64_tr_b16 a[56:57], v26 offset:16384
    ds_read_b64_tr_b16 a[58:59], v26 offset:16896
    ds_read_b64_tr_b16 a[60:61], v27 offset:16384
    ds_read_b64_tr_b16 a[62:63], v27 offset:16896
    s_addk_i32 m0, 0x400
    v_mfma_f32_16x16x32_bf16 v[232:235], a[40:43], a[104:107], v[232:235]
    ds_read_b64_tr_b16 a[64:65], v20 offset:0
    ds_read_b64_tr_b16 a[66:67], v20 offset:512
    ds_read_b64_tr_b16 a[68:69], v21 offset:0
    ds_read_b64_tr_b16 a[70:71], v21 offset:512
    buffer_load_dwordx4 v14, s[16:19], s74 offen lds
    v_mfma_f32_16x16x32_bf16 v[236:239], a[44:47], a[104:107], v[236:239]
    ds_read_b64_tr_b16 a[72:73], v22 offset:0
    ds_read_b64_tr_b16 a[74:75], v22 offset:512
    ds_read_b64_tr_b16 a[76:77], v23 offset:0
    ds_read_b64_tr_b16 a[78:79], v23 offset:512
    s_addk_i32 m0, 0x400
    v_mfma_f32_16x16x32_bf16 v[240:243], a[32:35], a[108:111], v[240:243]
    ds_read_b128 a[16:19], v29 offset:12288
    ds_read_b128 a[20:23], v29 offset:14336
    ds_read_b128 a[24:27], v31 offset:0
    ds_read_b128 a[28:31], v31 offset:2048
    buffer_load_dwordx4 v15, s[16:19], s74 offen lds
    v_mfma_f32_16x16x32_bf16 v[244:247], a[36:39], a[108:111], v[244:247]
    v_mfma_f32_16x16x32_bf16 v[248:251], a[40:43], a[108:111], v[248:251]
    v_mfma_f32_16x16x32_bf16 v[252:255], a[44:47], a[108:111], v[252:255]
    s_waitcnt lgkmcnt(0)
    v_mfma_f32_16x16x32_bf16 v[128:131], a[0:3], a[48:51], v[128:131]
    s_addk_i32 m0, 0x400
    v_mfma_f32_16x16x32_bf16 v[132:135], a[4:7], a[48:51], v[132:135]
    s_add_u32 s74, s86, s62
    v_mfma_f32_16x16x32_bf16 v[136:139], a[8:11], a[48:51], v[136:139]
    buffer_load_dwordx4 v12, s[16:19], s74 offen lds
    v_mfma_f32_16x16x32_bf16 v[140:143], a[12:15], a[48:51], v[140:143]
    s_addk_i32 m0, 0x400
    v_mfma_f32_16x16x32_bf16 v[144:147], a[0:3], a[52:55], v[144:147]
    buffer_load_dwordx4 v13, s[16:19], s74 offen lds
    v_mfma_f32_16x16x32_bf16 v[148:151], a[4:7], a[52:55], v[148:151]
    s_addk_i32 m0, 0x400
    v_mfma_f32_16x16x32_bf16 v[152:155], a[8:11], a[52:55], v[152:155]
    buffer_load_dwordx4 v14, s[16:19], s74 offen lds
    v_mfma_f32_16x16x32_bf16 v[156:159], a[12:15], a[52:55], v[156:159]
    s_addk_i32 m0, 0x400
    v_mfma_f32_16x16x32_bf16 v[160:163], a[0:3], a[56:59], v[160:163]
    buffer_load_dwordx4 v15, s[16:19], s74 offen lds
    v_mfma_f32_16x16x32_bf16 v[164:167], a[4:7], a[56:59], v[164:167]
    s_addk_i32 m0, 0x400
    v_mfma_f32_16x16x32_bf16 v[168:171], a[8:11], a[56:59], v[168:171]
    s_add_u32 s88, s87, s66
    v_mfma_f32_16x16x32_bf16 v[172:175], a[12:15], a[56:59], v[172:175]
    s_mov_b32 s75, s88
    v_mfma_f32_16x16x32_bf16 v[176:179], a[0:3], a[60:63], v[176:179]
    buffer_load_dwordx4 v16, s[20:23], s75 offen lds
    v_mfma_f32_16x16x32_bf16 v[180:183], a[4:7], a[60:63], v[180:183]
    s_addk_i32 m0, 0x400
    v_mfma_f32_16x16x32_bf16 v[184:187], a[8:11], a[60:63], v[184:187]
    buffer_load_dwordx4 v17, s[20:23], s75 offen lds
    v_mfma_f32_16x16x32_bf16 v[188:191], a[12:15], a[60:63], v[188:191]
    s_addk_i32 m0, 0x400
    v_mfma_f32_16x16x32_bf16 v[192:195], a[0:3], a[64:67], v[192:195]
    buffer_load_dwordx4 v18, s[20:23], s75 offen lds
    v_mfma_f32_16x16x32_bf16 v[196:199], a[4:7], a[64:67], v[196:199]
    s_addk_i32 m0, 0x400
    v_mfma_f32_16x16x32_bf16 v[200:203], a[8:11], a[64:67], v[200:203]
    buffer_load_dwordx4 v19, s[20:23], s75 offen lds
    v_mfma_f32_16x16x32_bf16 v[204:207], a[12:15], a[64:67], v[204:207]
    s_add_u32 m0, s41, 8192
    v_mfma_f32_16x16x32_bf16 v[208:211], a[0:3], a[68:71], v[208:211]
    s_add_u32 s75, s88, 229376
    v_mfma_f32_16x16x32_bf16 v[212:215], a[4:7], a[68:71], v[212:215]
    buffer_load_dwordx4 v16, s[20:23], s75 offen lds
    v_mfma_f32_16x16x32_bf16 v[216:219], a[8:11], a[68:71], v[216:219]
    v_mfma_f32_16x16x32_bf16 v[220:223], a[12:15], a[68:71], v[220:223]
    s_waitcnt vmcnt(13)
    ds_read_b64_tr_b16 a[80:81], v20 offset:4096
    ds_read_b64_tr_b16 a[82:83], v20 offset:4608
    s_addk_i32 m0, 0x400
    v_mfma_f32_16x16x32_bf16 v[224:227], a[0:3], a[72:75], v[224:227]
    ds_read_b64_tr_b16 a[84:85], v21 offset:4096
    ds_read_b64_tr_b16 a[86:87], v21 offset:4608
    ds_read_b64_tr_b16 a[88:89], v22 offset:4096
    buffer_load_dwordx4 v17, s[20:23], s75 offen lds
    v_mfma_f32_16x16x32_bf16 v[228:231], a[4:7], a[72:75], v[228:231]
    ds_read_b64_tr_b16 a[90:91], v22 offset:4608
    ds_read_b64_tr_b16 a[92:93], v23 offset:4096
    ds_read_b64_tr_b16 a[94:95], v23 offset:4608
    s_addk_i32 m0, 0x400
    v_mfma_f32_16x16x32_bf16 v[232:235], a[8:11], a[72:75], v[232:235]
    ds_read_b64_tr_b16 a[96:97], v24 offset:32768
    ds_read_b64_tr_b16 a[98:99], v24 offset:33280
    ds_read_b64_tr_b16 a[100:101], v25 offset:32768
    buffer_load_dwordx4 v18, s[20:23], s75 offen lds
    v_mfma_f32_16x16x32_bf16 v[236:239], a[12:15], a[72:75], v[236:239]
    ds_read_b64_tr_b16 a[102:103], v25 offset:33280
    ds_read_b64_tr_b16 a[104:105], v26 offset:32768
    ds_read_b64_tr_b16 a[106:107], v26 offset:33280
    s_addk_i32 m0, 0x400
    v_mfma_f32_16x16x32_bf16 v[240:243], a[0:3], a[76:79], v[240:243]
    ds_read_b64_tr_b16 a[108:109], v27 offset:32768
    ds_read_b64_tr_b16 a[110:111], v27 offset:33280
    buffer_load_dwordx4 v19, s[20:23], s75 offen lds
    v_mfma_f32_16x16x32_bf16 v[244:247], a[4:7], a[76:79], v[244:247]
    v_mfma_f32_16x16x32_bf16 v[248:251], a[8:11], a[76:79], v[248:251]
    v_mfma_f32_16x16x32_bf16 v[252:255], a[12:15], a[76:79], v[252:255]
    s_waitcnt lgkmcnt(0)
    v_mfma_f32_16x16x32_bf16 v[128:131], a[16:19], a[80:83], v[128:131]
    s_addk_i32 m0, 0x400
    v_mfma_f32_16x16x32_bf16 v[132:135], a[20:23], a[80:83], v[132:135]
    s_add_u32 s75, s88, 28672
    v_mfma_f32_16x16x32_bf16 v[136:139], a[24:27], a[80:83], v[136:139]
    buffer_load_dwordx4 v16, s[20:23], s75 offen lds
    v_mfma_f32_16x16x32_bf16 v[140:143], a[28:31], a[80:83], v[140:143]
    s_addk_i32 m0, 0x400
    v_mfma_f32_16x16x32_bf16 v[144:147], a[16:19], a[84:87], v[144:147]
    buffer_load_dwordx4 v17, s[20:23], s75 offen lds
    v_mfma_f32_16x16x32_bf16 v[148:151], a[20:23], a[84:87], v[148:151]
    s_addk_i32 m0, 0x400
    v_mfma_f32_16x16x32_bf16 v[152:155], a[24:27], a[84:87], v[152:155]
    buffer_load_dwordx4 v18, s[20:23], s75 offen lds
    v_mfma_f32_16x16x32_bf16 v[156:159], a[28:31], a[84:87], v[156:159]
    s_addk_i32 m0, 0x400
    v_mfma_f32_16x16x32_bf16 v[160:163], a[16:19], a[88:91], v[160:163]
    buffer_load_dwordx4 v19, s[20:23], s75 offen lds
    v_mfma_f32_16x16x32_bf16 v[164:167], a[20:23], a[88:91], v[164:167]
    s_add_u32 m0, s42, 0
    v_mfma_f32_16x16x32_bf16 v[168:171], a[24:27], a[88:91], v[168:171]
    s_add_u32 s75, s88, 258048
    v_mfma_f32_16x16x32_bf16 v[172:175], a[28:31], a[88:91], v[172:175]
    v_mfma_f32_16x16x32_bf16 v[176:179], a[16:19], a[92:95], v[176:179]
    buffer_load_dwordx4 v16, s[20:23], s75 offen lds
    v_mfma_f32_16x16x32_bf16 v[180:183], a[20:23], a[92:95], v[180:183]
    s_addk_i32 m0, 0x400
    v_mfma_f32_16x16x32_bf16 v[184:187], a[24:27], a[92:95], v[184:187]
    buffer_load_dwordx4 v17, s[20:23], s75 offen lds
    v_mfma_f32_16x16x32_bf16 v[188:191], a[28:31], a[92:95], v[188:191]
    s_addk_i32 m0, 0x400
    v_mfma_f32_16x16x32_bf16 v[192:195], a[16:19], a[96:99], v[192:195]
    buffer_load_dwordx4 v18, s[20:23], s75 offen lds
    v_mfma_f32_16x16x32_bf16 v[196:199], a[20:23], a[96:99], v[196:199]
    s_addk_i32 m0, 0x400
    v_mfma_f32_16x16x32_bf16 v[200:203], a[24:27], a[96:99], v[200:203]
    buffer_load_dwordx4 v19, s[20:23], s75 offen lds
    v_mfma_f32_16x16x32_bf16 v[204:207], a[28:31], a[96:99], v[204:207]
    s_add_u32 m0, s42, 16384
    v_mfma_f32_16x16x32_bf16 v[208:211], a[16:19], a[100:103], v[208:211]
    s_add_u32 s74, s85, s63
    v_mfma_f32_16x16x32_bf16 v[212:215], a[20:23], a[100:103], v[212:215]
    buffer_load_dwordx4 v12, s[16:19], s74 offen lds
    v_mfma_f32_16x16x32_bf16 v[216:219], a[24:27], a[100:103], v[216:219]
    v_mfma_f32_16x16x32_bf16 v[220:223], a[28:31], a[100:103], v[220:223]
    s_waitcnt vmcnt(9)
    ds_read_b128 a[32:35], v28 offset:16384
    ds_read_b128 a[36:39], v28 offset:18432
    ds_read_b128 a[40:43], v28 offset:20480
    ds_read_b128 a[44:47], v28 offset:22528
    s_addk_i32 m0, 0x400
    v_mfma_f32_16x16x32_bf16 v[224:227], a[16:19], a[104:107], v[224:227]
    ds_read_b64_tr_b16 a[48:49], v20 offset:24576
    ds_read_b64_tr_b16 a[50:51], v20 offset:25088
    ds_read_b64_tr_b16 a[52:53], v21 offset:24576
    ds_read_b64_tr_b16 a[54:55], v21 offset:25088
    buffer_load_dwordx4 v13, s[16:19], s74 offen lds
    v_mfma_f32_16x16x32_bf16 v[228:231], a[20:23], a[104:107], v[228:231]
    ds_read_b64_tr_b16 a[56:57], v22 offset:24576
    ds_read_b64_tr_b16 a[58:59], v22 offset:25088
    ds_read_b64_tr_b16 a[60:61], v23 offset:24576
    ds_read_b64_tr_b16 a[62:63], v23 offset:25088
    s_addk_i32 m0, 0x400
    v_mfma_f32_16x16x32_bf16 v[232:235], a[24:27], a[104:107], v[232:235]
    ds_read_b64_tr_b16 a[64:65], v20 offset:8192
    ds_read_b64_tr_b16 a[66:67], v20 offset:8704
    ds_read_b64_tr_b16 a[68:69], v21 offset:8192
    ds_read_b64_tr_b16 a[70:71], v21 offset:8704
    buffer_load_dwordx4 v14, s[16:19], s74 offen lds
    v_mfma_f32_16x16x32_bf16 v[236:239], a[28:31], a[104:107], v[236:239]
    ds_read_b64_tr_b16 a[72:73], v22 offset:8192
    ds_read_b64_tr_b16 a[74:75], v22 offset:8704
    ds_read_b64_tr_b16 a[76:77], v23 offset:8192
    ds_read_b64_tr_b16 a[78:79], v23 offset:8704
    s_addk_i32 m0, 0x400
    v_mfma_f32_16x16x32_bf16 v[240:243], a[16:19], a[108:111], v[240:243]
    ds_read_b128 a[0:3], v29 offset:16384
    ds_read_b128 a[4:7], v29 offset:18432
    ds_read_b128 a[8:11], v29 offset:20480
    ds_read_b128 a[12:15], v29 offset:22528
    buffer_load_dwordx4 v15, s[16:19], s74 offen lds
    v_mfma_f32_16x16x32_bf16 v[244:247], a[20:23], a[108:111], v[244:247]
    v_mfma_f32_16x16x32_bf16 v[248:251], a[24:27], a[108:111], v[248:251]
    v_mfma_f32_16x16x32_bf16 v[252:255], a[28:31], a[108:111], v[252:255]
    s_waitcnt lgkmcnt(0)
    v_cvt_pk_bf16_f32 v64, v128, v129
    v_cvt_pk_bf16_f32 v65, v130, v131
    v_mfma_f32_16x16x32_bf16 v[128:131], a[32:35], a[48:51], 0
    v_cvt_pk_bf16_f32 v66, v132, v133
    v_cvt_pk_bf16_f32 v67, v134, v135
    v_mfma_f32_16x16x32_bf16 v[132:135], a[36:39], a[48:51], 0
    s_waitcnt vmcnt(4)
    ds_read_b64_tr_b16 a[80:81], v20 offset:12288
    s_add_u32 m0, s41, 0
    s_add_u32 s74, s86, s63
    buffer_load_dwordx4 v12, s[16:19], s74 offen lds
    v_cvt_pk_bf16_f32 v68, v136, v137
    v_cvt_pk_bf16_f32 v69, v138, v139
    v_mfma_f32_16x16x32_bf16 v[136:139], a[40:43], a[48:51], 0
    v_cvt_pk_bf16_f32 v70, v140, v141
    v_cvt_pk_bf16_f32 v71, v142, v143
    v_mfma_f32_16x16x32_bf16 v[140:143], a[44:47], a[48:51], 0
    ds_read_b64_tr_b16 a[82:83], v20 offset:12800
    v_cvt_pk_bf16_f32 v72, v144, v145
    v_cvt_pk_bf16_f32 v73, v146, v147
    v_mfma_f32_16x16x32_bf16 v[144:147], a[32:35], a[52:55], 0
    v_cvt_pk_bf16_f32 v74, v148, v149
    v_cvt_pk_bf16_f32 v75, v150, v151
    v_mfma_f32_16x16x32_bf16 v[148:151], a[36:39], a[52:55], 0
    ds_read_b64_tr_b16 a[84:85], v21 offset:12288
    s_addk_i32 m0, 0x400
    s_nop 0
    buffer_load_dwordx4 v13, s[16:19], s74 offen lds
    v_cvt_pk_bf16_f32 v76, v152, v153
    v_cvt_pk_bf16_f32 v77, v154, v155
    v_mfma_f32_16x16x32_bf16 v[152:155], a[40:43], a[52:55], 0
    v_cvt_pk_bf16_f32 v78, v156, v157
    v_cvt_pk_bf16_f32 v79, v158, v159
    v_mfma_f32_16x16x32_bf16 v[156:159], a[44:47], a[52:55], 0
    ds_read_b64_tr_b16 a[86:87], v21 offset:12800
    v_cvt_pk_bf16_f32 v80, v160, v161
    v_cvt_pk_bf16_f32 v81, v162, v163
    v_mfma_f32_16x16x32_bf16 v[160:163], a[32:35], a[56:59], 0
    v_cvt_pk_bf16_f32 v82, v164, v165
    v_cvt_pk_bf16_f32 v83, v166, v167
    v_mfma_f32_16x16x32_bf16 v[164:167], a[36:39], a[56:59], 0
    ds_read_b64_tr_b16 a[88:89], v22 offset:12288
    s_addk_i32 m0, 0x400
    s_nop 0
    buffer_load_dwordx4 v14, s[16:19], s74 offen lds
    v_cvt_pk_bf16_f32 v84, v168, v169
    v_cvt_pk_bf16_f32 v85, v170, v171
    v_mfma_f32_16x16x32_bf16 v[168:171], a[40:43], a[56:59], 0
    v_cvt_pk_bf16_f32 v86, v172, v173
    v_cvt_pk_bf16_f32 v87, v174, v175
    v_mfma_f32_16x16x32_bf16 v[172:175], a[44:47], a[56:59], 0
    ds_read_b64_tr_b16 a[90:91], v22 offset:12800
    v_cvt_pk_bf16_f32 v88, v176, v177
    v_cvt_pk_bf16_f32 v89, v178, v179
    v_mfma_f32_16x16x32_bf16 v[176:179], a[32:35], a[60:63], 0
    v_cvt_pk_bf16_f32 v90, v180, v181
    v_cvt_pk_bf16_f32 v91, v182, v183
    v_mfma_f32_16x16x32_bf16 v[180:183], a[36:39], a[60:63], 0
    ds_read_b64_tr_b16 a[92:93], v23 offset:12288
    s_addk_i32 m0, 0x400
    s_nop 0
    buffer_load_dwordx4 v15, s[16:19], s74 offen lds
    v_cvt_pk_bf16_f32 v92, v184, v185
    v_cvt_pk_bf16_f32 v93, v186, v187
    v_mfma_f32_16x16x32_bf16 v[184:187], a[40:43], a[60:63], 0
    v_cvt_pk_bf16_f32 v94, v188, v189
    v_cvt_pk_bf16_f32 v95, v190, v191
    v_mfma_f32_16x16x32_bf16 v[188:191], a[44:47], a[60:63], 0
    ds_read_b64_tr_b16 a[94:95], v23 offset:12800
    v_cvt_pk_bf16_f32 v96, v192, v193
    v_cvt_pk_bf16_f32 v97, v194, v195
    v_mfma_f32_16x16x32_bf16 v[192:195], a[32:35], a[64:67], 0
    v_cvt_pk_bf16_f32 v98, v196, v197
    v_cvt_pk_bf16_f32 v99, v198, v199
    v_mfma_f32_16x16x32_bf16 v[196:199], a[36:39], a[64:67], 0
    ds_read_b64_tr_b16 a[96:97], v24 offset:0
    s_addk_i32 m0, 0x400
    s_add_u32 s88, s87, s67
    s_mov_b32 s75, s88
    buffer_load_dwordx4 v16, s[20:23], s75 offen lds
    v_cvt_pk_bf16_f32 v100, v200, v201
    v_cvt_pk_bf16_f32 v101, v202, v203
    v_mfma_f32_16x16x32_bf16 v[200:203], a[40:43], a[64:67], 0
    v_cvt_pk_bf16_f32 v102, v204, v205
    v_cvt_pk_bf16_f32 v103, v206, v207
    v_mfma_f32_16x16x32_bf16 v[204:207], a[44:47], a[64:67], 0
    ds_read_b64_tr_b16 a[98:99], v24 offset:512
    s_addk_i32 m0, 0x400
    s_nop 0
    buffer_load_dwordx4 v17, s[20:23], s75 offen lds
    v_cvt_pk_bf16_f32 v104, v208, v209
    v_cvt_pk_bf16_f32 v105, v210, v211
    v_mfma_f32_16x16x32_bf16 v[208:211], a[32:35], a[68:71], 0
    v_cvt_pk_bf16_f32 v106, v212, v213
    v_cvt_pk_bf16_f32 v107, v214, v215
    v_mfma_f32_16x16x32_bf16 v[212:215], a[36:39], a[68:71], 0
    ds_read_b64_tr_b16 a[100:101], v25 offset:0
    s_addk_i32 m0, 0x400
    s_nop 0
    buffer_load_dwordx4 v18, s[20:23], s75 offen lds
    v_cvt_pk_bf16_f32 v108, v216, v217
    v_cvt_pk_bf16_f32 v109, v218, v219
    v_mfma_f32_16x16x32_bf16 v[216:219], a[40:43], a[68:71], 0
    v_cvt_pk_bf16_f32 v110, v220, v221
    v_cvt_pk_bf16_f32 v111, v222, v223
    v_mfma_f32_16x16x32_bf16 v[220:223], a[44:47], a[68:71], 0
    ds_read_b64_tr_b16 a[102:103], v25 offset:512
    s_addk_i32 m0, 0x400
    s_nop 0
    buffer_load_dwordx4 v19, s[20:23], s75 offen lds
    v_cvt_pk_bf16_f32 v112, v224, v225
    v_cvt_pk_bf16_f32 v113, v226, v227
    v_mfma_f32_16x16x32_bf16 v[224:227], a[32:35], a[72:75], 0
    v_cvt_pk_bf16_f32 v114, v228, v229
    v_cvt_pk_bf16_f32 v115, v230, v231
    v_mfma_f32_16x16x32_bf16 v[228:231], a[36:39], a[72:75], 0
    ds_read_b64_tr_b16 a[104:105], v26 offset:0
    s_add_u32 m0, s42, 32768
    s_add_u32 s75, s88, 229376
    buffer_load_dwordx4 v16, s[20:23], s75 offen lds
    v_cvt_pk_bf16_f32 v116, v232, v233
    v_cvt_pk_bf16_f32 v117, v234, v235
    v_mfma_f32_16x16x32_bf16 v[232:235], a[40:43], a[72:75], 0
    v_cvt_pk_bf16_f32 v118, v236, v237
    v_cvt_pk_bf16_f32 v119, v238, v239
    v_mfma_f32_16x16x32_bf16 v[236:239], a[44:47], a[72:75], 0
    ds_read_b64_tr_b16 a[106:107], v26 offset:512
    s_addk_i32 m0, 0x400
    s_nop 0
    buffer_load_dwordx4 v17, s[20:23], s75 offen lds
    v_cvt_pk_bf16_f32 v120, v240, v241
    v_cvt_pk_bf16_f32 v121, v242, v243
    v_mfma_f32_16x16x32_bf16 v[240:243], a[32:35], a[76:79], 0
    v_cvt_pk_bf16_f32 v122, v244, v245
    v_cvt_pk_bf16_f32 v123, v246, v247
    v_mfma_f32_16x16x32_bf16 v[244:247], a[36:39], a[76:79], 0
    ds_read_b64_tr_b16 a[108:109], v27 offset:0
    s_addk_i32 m0, 0x400
    s_nop 0
    buffer_load_dwordx4 v18, s[20:23], s75 offen lds
    v_cvt_pk_bf16_f32 v124, v248, v249
    v_cvt_pk_bf16_f32 v125, v250, v251
    v_mfma_f32_16x16x32_bf16 v[248:251], a[40:43], a[76:79], 0
    v_cvt_pk_bf16_f32 v126, v252, v253
    v_cvt_pk_bf16_f32 v127, v254, v255
    v_mfma_f32_16x16x32_bf16 v[252:255], a[44:47], a[76:79], 0
    ds_read_b64_tr_b16 a[110:111], v27 offset:512
    s_addk_i32 m0, 0x400
    s_nop 0
    buffer_load_dwordx4 v19, s[20:23], s75 offen lds
    v_mov_b32 v53, 0
    buffer_load_dwordx4 v[56:59], v53, s[96:99], s83 offen sc1
    s_waitcnt lgkmcnt(0)
    v_mfma_f32_16x16x32_bf16 v[128:131], a[0:3], a[80:83], v[128:131]
    s_add_u32 m0, s41, 16384
    v_mfma_f32_16x16x32_bf16 v[132:135], a[4:7], a[80:83], v[132:135]
    s_add_u32 s75, s88, 28672
    v_mfma_f32_16x16x32_bf16 v[136:139], a[8:11], a[80:83], v[136:139]
    buffer_load_dwordx4 v16, s[20:23], s75 offen lds
    v_mfma_f32_16x16x32_bf16 v[140:143], a[12:15], a[80:83], v[140:143]
    s_addk_i32 m0, 0x400
    v_mfma_f32_16x16x32_bf16 v[144:147], a[0:3], a[84:87], v[144:147]
    buffer_load_dwordx4 v17, s[20:23], s75 offen lds
    v_mfma_f32_16x16x32_bf16 v[148:151], a[4:7], a[84:87], v[148:151]
    s_addk_i32 m0, 0x400
    v_mfma_f32_16x16x32_bf16 v[152:155], a[8:11], a[84:87], v[152:155]
    buffer_load_dwordx4 v18, s[20:23], s75 offen lds
    v_mfma_f32_16x16x32_bf16 v[156:159], a[12:15], a[84:87], v[156:159]
    s_addk_i32 m0, 0x400
    v_mfma_f32_16x16x32_bf16 v[160:163], a[0:3], a[88:91], v[160:163]
    buffer_load_dwordx4 v19, s[20:23], s75 offen lds
    v_mfma_f32_16x16x32_bf16 v[164:167], a[4:7], a[88:91], v[164:167]
    s_addk_i32 m0, 0x400
    v_mfma_f32_16x16x32_bf16 v[168:171], a[8:11], a[88:91], v[168:171]
    s_add_u32 s75, s88, 258048
    v_mfma_f32_16x16x32_bf16 v[172:175], a[12:15], a[88:91], v[172:175]
    v_mfma_f32_16x16x32_bf16 v[176:179], a[0:3], a[92:95], v[176:179]
    buffer_load_dwordx4 v16, s[20:23], s75 offen lds
    v_mfma_f32_16x16x32_bf16 v[180:183], a[4:7], a[92:95], v[180:183]
    s_addk_i32 m0, 0x400
    v_mfma_f32_16x16x32_bf16 v[184:187], a[8:11], a[92:95], v[184:187]
    buffer_load_dwordx4 v17, s[20:23], s75 offen lds
    v_mfma_f32_16x16x32_bf16 v[188:191], a[12:15], a[92:95], v[188:191]
    s_addk_i32 m0, 0x400
    v_mfma_f32_16x16x32_bf16 v[192:195], a[0:3], a[96:99], v[192:195]
    buffer_load_dwordx4 v18, s[20:23], s75 offen lds
    v_mfma_f32_16x16x32_bf16 v[196:199], a[4:7], a[96:99], v[196:199]
    s_addk_i32 m0, 0x400
    v_mfma_f32_16x16x32_bf16 v[200:203], a[8:11], a[96:99], v[200:203]
    buffer_load_dwordx4 v19, s[20:23], s75 offen lds
    v_mfma_f32_16x16x32_bf16 v[204:207], a[12:15], a[96:99], v[204:207]
    s_addk_i32 m0, 0x400
    v_mfma_f32_16x16x32_bf16 v[208:211], a[0:3], a[100:103], v[208:211]
    s_add_u32 s74, s85, s64
    v_mfma_f32_16x16x32_bf16 v[212:215], a[4:7], a[100:103], v[212:215]
    buffer_load_dwordx4 v12, s[16:19], s74 offen lds
    v_mfma_f32_16x16x32_bf16 v[216:219], a[8:11], a[100:103], v[216:219]
    v_mfma_f32_16x16x32_bf16 v[220:223], a[12:15], a[100:103], v[220:223]
    s_waitcnt vmcnt(10)
    ds_read_b128 a[16:19], v30 offset:16384
    ds_read_b128 a[20:23], v30 offset:18432
    ds_read_b128 a[24:27], v28 offset:0
    ds_read_b128 a[28:31], v28 offset:2048
    s_addk_i32 m0, 0x400
    v_mfma_f32_16x16x32_bf16 v[224:227], a[0:3], a[104:107], v[224:227]
    ds_read_b64_tr_b16 a[48:49], v20 offset:4096
    ds_read_b64_tr_b16 a[50:51], v20 offset:4608
    ds_read_b64_tr_b16 a[52:53], v21 offset:4096
    ds_read_b64_tr_b16 a[54:55], v21 offset:4608
    buffer_load_dwordx4 v13, s[16:19], s74 offen lds
    v_mfma_f32_16x16x32_bf16 v[228:231], a[4:7], a[104:107], v[228:231]
    ds_read_b64_tr_b16 a[56:57], v22 offset:4096
    ds_read_b64_tr_b16 a[58:59], v22 offset:4608
    ds_read_b64_tr_b16 a[60:61], v23 offset:4096
    ds_read_b64_tr_b16 a[62:63], v23 offset:4608
    s_addk_i32 m0, 0x400
    v_mfma_f32_16x16x32_bf16 v[232:235], a[8:11], a[104:107], v[232:235]
    ds_read_b64_tr_b16 a[64:65], v24 offset:32768
    ds_read_b64_tr_b16 a[66:67], v24 offset:33280
    ds_read_b64_tr_b16 a[68:69], v25 offset:32768
    ds_read_b64_tr_b16 a[70:71], v25 offset:33280
    buffer_load_dwordx4 v14, s[16:19], s74 offen lds
    v_mfma_f32_16x16x32_bf16 v[236:239], a[12:15], a[104:107], v[236:239]
    ds_read_b64_tr_b16 a[72:73], v26 offset:32768
    ds_read_b64_tr_b16 a[74:75], v26 offset:33280
    ds_read_b64_tr_b16 a[76:77], v27 offset:32768
    ds_read_b64_tr_b16 a[78:79], v27 offset:33280
    s_addk_i32 m0, 0x400
    v_mfma_f32_16x16x32_bf16 v[240:243], a[0:3], a[108:111], v[240:243]
    ds_read_b128 a[32:35], v31 offset:16384
    ds_read_b128 a[36:39], v31 offset:18432
    ds_read_b128 a[40:43], v29 offset:0
    ds_read_b128 a[44:47], v29 offset:2048
    buffer_load_dwordx4 v15, s[16:19], s74 offen lds
    v_mfma_f32_16x16x32_bf16 v[244:247], a[4:7], a[108:111], v[244:247]
    v_mfma_f32_16x16x32_bf16 v[248:251], a[8:11], a[108:111], v[248:251]
    v_mfma_f32_16x16x32_bf16 v[252:255], a[12:15], a[108:111], v[252:255]
    s_waitcnt vmcnt(12)
    s_cmp_eq_u32 s34, 0
    s_cbranch_scc0 L_pready
    v_min_u32 v56, v56, v57
    v_min_u32 v58, v58, v59
    v_min_u32 v56, v56, v58
    s_nop 0
    v_readfirstlane_b32 s89, v56
    s_nop 3
    s_cmp_ge_u32 s89, 4
    s_cbranch_scc1 L_pready
    s_mov_b32 s73, 0
L_spin:
    s_sleep 8
    buffer_load_dwordx4 v[56:59], v53, s[96:99], s83 offen sc1
    s_waitcnt vmcnt(0)
    v_min_u32 v56, v56, v57
    v_min_u32 v58, v58, v59
    v_min_u32 v56, v56, v58
    s_nop 0
    v_readfirstlane_b32 s89, v56
    s_add_u32 s73, s73, 1
    s_cmp_ge_u32 s73, 0x40000
    s_cbranch_scc1 L_pready
    s_nop 0
    s_cmp_ge_u32 s89, 4
    s_cbranch_scc0 L_spin
L_pready:
    s_barrier
    buffer_load_dwordx4 a[192:195], v44, s[24:27], s77 offen offset:0 sc1
    buffer_load_dwordx4 a[196:199], v44, s[24:27], s77 offen offset:1024 sc1
    buffer_load_dwordx4 a[200:203], v44, s[24:27], s78 offen offset:0 sc1
    buffer_load_dwordx4 a[204:207], v44, s[24:27], s78 offen offset:1024 sc1
    buffer_load_dwordx4 a[208:211], v44, s[24:27], s77 offen offset:2048 sc1
    buffer_load_dwordx4 a[212:215], v44, s[24:27], s77 offen offset:3072 sc1
    buffer_load_dwordx4 a[216:219], v44, s[24:27], s78 offen offset:2048 sc1
    buffer_load_dwordx4 a[220:223], v44, s[24:27], s78 offen offset:3072 sc1
    buffer_load_dwordx4 a[224:227], v44, s[24:27], s79 offen offset:0 sc1
    buffer_load_dwordx4 a[228:231], v44, s[24:27], s79 offen offset:1024 sc1
    buffer_load_dwordx4 a[232:235], v44, s[24:27], s80 offen offset:0 sc1
    buffer_load_dwordx4 a[236:239], v44, s[24:27], s80 offen offset:1024 sc1
    buffer_load_dwordx4 a[240:243], v44, s[24:27], s79 offen offset:2048 sc1
    buffer_load_dwordx4 a[244:247], v44, s[24:27], s79 offen offset:3072 sc1
    buffer_load_dwordx4 a[248:251], v44, s[24:27], s80 offen offset:2048 sc1
    buffer_load_dwordx4 a[252:255], v44, s[24:27], s80 offen offset:3072 sc1
    s_waitcnt lgkmcnt(0)
    v_mfma_f32_16x16x32_bf16 v[128:131], a[16:19], a[48:51], v[128:131]
    s_add_u32 m0, s41, 8192
    v_mfma_f32_16x16x32_bf16 v[132:135], a[20:23], a[48:51], v[132:135]
    s_add_u32 s74, s86, s64
    v_mfma_f32_16x16x32_bf16 v[136:139], a[24:27], a[48:51], v[136:139]
    buffer_load_dwordx4 v12, s[16:19], s74 offen lds
    v_mfma_f32_16x16x32_bf16 v[140:143], a[28:31], a[48:51], v[140:143]
    s_addk_i32 m0, 0x400
    v_mfma_f32_16x16x32_bf16 v[144:147], a[16:19], a[52:55], v[144:147]
    buffer_load_dwordx4 v13, s[16:19], s74 offen lds
    v_mfma_f32_16x16x32_bf16 v[148:151], a[20:23], a[52:55], v[148:151]
    s_addk_i32 m0, 0x400
    v_mfma_f32_16x16x32_bf16 v[152:155], a[24:27], a[52:55], v[152:155]
    buffer_load_dwordx4 v14, s[16:19], s74 offen lds
    v_mfma_f32_16x16x32_bf16 v[156:159], a[28:31], a[52:55], v[156:159]
    s_addk_i32 m0, 0x400
    v_mfma_f32_16x16x32_bf16 v[160:163], a[16:19], a[56:59], v[160:163]
    buffer_load_dwordx4 v15, s[16:19], s74 offen lds
    v_mfma_f32_16x16x32_bf16 v[164:167], a[20:23], a[56:59], v[164:167]
    s_addk_i32 m0, 0x400
    v_mfma_f32_16x16x32_bf16 v[168:171], a[24:27], a[56:59], v[168:171]
    s_add_u32 s88, s87, s68
    v_mfma_f32_16x16x32_bf16 v[172:175], a[28:31], a[56:59], v[172:175]
    s_mov_b32 s75, s88
    v_mfma_f32_16x16x32_bf16 v[176:179], a[16:19], a[60:63], v[176:179]
    buffer_load_dwordx4 v16, s[20:23], s75 offen lds
    v_mfma_f32_16x16x32_bf16 v[180:183], a[20:23], a[60:63], v[180:183]
    s_addk_i32 m0, 0x400
    v_mfma_f32_16x16x32_bf16 v[184:187], a[24:27], a[60:63], v[184:187]
    buffer_load_dwordx4 v17, s[20:23], s75 offen lds
    v_mfma_f32_16x16x32_bf16 v[188:191], a[28:31], a[60:63], v[188:191]
    s_addk_i32 m0, 0x400
    v_mfma_f32_16x16x32_bf16 v[192:195], a[16:19], a[64:67], v[192:195]
    buffer_load_dwordx4 v18, s[20:23], s75 offen lds
    v_mfma_f32_16x16x32_bf16 v[196:199], a[20:23], a[64:67], v[196:199]
    s_addk_i32 m0, 0x400
    v_mfma_f32_16x16x32_bf16 v[200:203], a[24:27], a[64:67], v[200:203]
    buffer_load_dwordx4 v19, s[20:23], s75 offen lds
    v_mfma_f32_16x16x32_bf16 v[204:207], a[28:31], a[64:67], v[204:207]
    s_add_u32 m0, s42, 0
    v_mfma_f32_16x16x32_bf16 v[208:211], a[16:19], a[68:71], v[208:211]
    s_add_u32 s75, s88, 229376
    v_mfma_f32_16x16x32_bf16 v[212:215], a[20:23], a[68:71], v[212:215]
    buffer_load_dwordx4 v16, s[20:23], s75 offen lds
    v_mfma_f32_16x16x32_bf16 v[216:219], a[24:27], a[68:71], v[216:219]
    v_mfma_f32_16x16x32_bf16 v[220:223], a[28:31], a[68:71], v[220:223]
    s_waitcnt vmcnt(29)
    ds_read_b64_tr_b16 a[80:81], v20 offset:16384
    ds_read_b64_tr_b16 a[82:83], v20 offset:16896
    s_addk_i32 m0, 0x400
    v_mfma_f32_16x16x32_bf16 v[224:227], a[16:19], a[72:75], v[224:227]
    ds_read_b64_tr_b16 a[84:85], v21 offset:16384
    ds_read_b64_tr_b16 a[86:87], v21 offset:16896
    ds_read_b64_tr_b16 a[88:89], v22 offset:16384
    buffer_load_dwordx4 v17, s[20:23], s75 offen lds
    v_mfma_f32_16x16x32_bf16 v[228:231], a[20:23], a[72:75], v[228:231]
    ds_read_b64_tr_b16 a[90:91], v22 offset:16896
    ds_read_b64_tr_b16 a[92:93], v23 offset:16384
    ds_read_b64_tr_b16 a[94:95], v23 offset:16896
    s_addk_i32 m0, 0x400
    v_mfma_f32_16x16x32_bf16 v[232:235], a[24:27], a[72:75], v[232:235]
    ds_read_b64_tr_b16 a[96:97], v20 offset:20480
    ds_read_b64_tr_b16 a[98:99], v20 offset:20992
    ds_read_b64_tr_b16 a[100:101], v21 offset:20480
    buffer_load_dwordx4 v18, s[20:23], s75 offen lds
    v_mfma_f32_16x16x32_bf16 v[236:239], a[28:31], a[72:75], v[236:239]
    ds_read_b64_tr_b16 a[102:103], v21 offset:20992
    ds_read_b64_tr_b16 a[104:105], v22 offset:20480
    ds_read_b64_tr_b16 a[106:107], v22 offset:20992
    s_addk_i32 m0, 0x400
    v_mfma_f32_16x16x32_bf16 v[240:243], a[16:19], a[76:79], v[240:243]
    ds_read_b64_tr_b16 a[108:109], v23 offset:20480
    ds_read_b64_tr_b16 a[110:111], v23 offset:20992
    buffer_load_dwordx4 v19, s[20:23], s75 offen lds
    v_mfma_f32_16x16x32_bf16 v[244:247], a[20:23], a[76:79], v[244:247]
    v_mfma_f32_16x16x32_bf16 v[248:251], a[24:27], a[76:79], v[248:251]
    v_mfma_f32_16x16x32_bf16 v[252:255], a[28:31], a[76:79], v[252:255]
    s_waitcnt lgkmcnt(0)
    v_mfma_f32_16x16x32_bf16 v[128:131], a[32:35], a[80:83], v[128:131]
    s_add_u32 m0, s42, 16384
    v_mfma_f32_16x16x32_bf16 v[132:135], a[36:39], a[80:83], v[132:135]
    s_add_u32 s75, s88, 28672
    v_mfma_f32_16x16x32_bf16 v[136:139], a[40:43], a[80:83], v[136:139]
    buffer_load_dwordx4 v16, s[20:23], s75 offen lds
    v_mfma_f32_16x16x32_bf16 v[140:143], a[44:47], a[80:83], v[140:143]
    s_addk_i32 m0, 0x400
    v_mfma_f32_16x16x32_bf16 v[144:147], a[32:35], a[84:87], v[144:147]
    buffer_load_dwordx4 v17, s[20:23], s75 offen lds
    v_mfma_f32_16x16x32_bf16 v[148:151], a[36:39], a[84:87], v[148:151]
    s_addk_i32 m0, 0x400
    v_mfma_f32_16x16x32_bf16 v[152:155], a[40:43], a[84:87], v[152:155]
    buffer_load_dwordx4 v18, s[20:23], s75 offen lds
    v_mfma_f32_16x16x32_bf16 v[156:159], a[44:47], a[84:87], v[156:159]
    s_addk_i32 m0, 0x400
    v_mfma_f32_16x16x32_bf16 v[160:163], a[32:35], a[88:91], v[160:163]
    buffer_load_dwordx4 v19, s[20:23], s75 offen lds
    v_mfma_f32_16x16x32_bf16 v[164:167], a[36:39], a[88:91], v[164:167]
    s_add_u32 m0, s41, 0
    v_mfma_f32_16x16x32_bf16 v[168:171], a[40:43], a[88:91], v[168:171]
    s_add_u32 s75, s88, 258048
    v_mfma_f32_16x16x32_bf16 v[172:175], a[44:47], a[88:91], v[172:175]
    v_mfma_f32_16x16x32_bf16 v[176:179], a[32:35], a[92:95], v[176:179]
    buffer_load_dwordx4 v16, s[20:23], s75 offen lds
    v_mfma_f32_16x16x32_bf16 v[180:183], a[36:39], a[92:95], v[180:183]
    s_addk_i32 m0, 0x400
    v_mfma_f32_16x16x32_bf16 v[184:187], a[40:43], a[92:95], v[184:187]
    buffer_load_dwordx4 v17, s[20:23], s75 offen lds
    v_mfma_f32_16x16x32_bf16 v[188:191], a[44:47], a[92:95], v[188:191]
    s_addk_i32 m0, 0x400
    v_mfma_f32_16x16x32_bf16 v[192:195], a[32:35], a[96:99], v[192:195]
    buffer_load_dwordx4 v18, s[20:23], s75 offen lds
    v_mfma_f32_16x16x32_bf16 v[196:199], a[36:39], a[96:99], v[196:199]
    s_addk_i32 m0, 0x400
    v_mfma_f32_16x16x32_bf16 v[200:203], a[40:43], a[96:99], v[200:203]
    buffer_load_dwordx4 v19, s[20:23], s75 offen lds
    v_mfma_f32_16x16x32_bf16 v[204:207], a[44:47], a[96:99], v[204:207]
    s_addk_i32 m0, 0x400
    v_mfma_f32_16x16x32_bf16 v[208:211], a[32:35], a[100:103], v[208:211]
    s_add_u32 s74, s85, s65
    v_mfma_f32_16x16x32_bf16 v[212:215], a[36:39], a[100:103], v[212:215]
    buffer_load_dwordx4 v12, s[16:19], s74 offen lds
    v_mfma_f32_16x16x32_bf16 v[216:219], a[40:43], a[100:103], v[216:219]
    v_mfma_f32_16x16x32_bf16 v[220:223], a[44:47], a[100:103], v[220:223]
    s_waitcnt vmcnt(9)
    ds_read_b128 a[0:3], v28 offset:24576
    ds_read_b128 a[4:7], v28 offset:26624
    ds_read_b128 a[8:11], v28 offset:8192
    ds_read_b128 a[12:15], v28 offset:10240
    s_addk_i32 m0, 0x400
    v_mfma_f32_16x16x32_bf16 v[224:227], a[32:35], a[104:107], v[224:227]
    ds_read_b64_tr_b16 a[48:49], v20 offset:12288
    ds_read_b64_tr_b16 a[50:51], v20 offset:12800
    ds_read_b64_tr_b16 a[52:53], v21 offset:12288
    ds_read_b64_tr_b16 a[54:55], v21 offset:12800
    buffer_load_dwordx4 v13, s[16:19], s74 offen lds
    v_mfma_f32_16x16x32_bf16 v[228:231], a[36:39], a[104:107], v[228:231]
    ds_read_b64_tr_b16 a[56:57], v22 offset:12288
    ds_read_b64_tr_b16 a[58:59], v22 offset:12800
    ds_read_b64_tr_b16 a[60:61], v23 offset:12288
    ds_read_b64_tr_b16 a[62:63], v23 offset:12800
    s_addk_i32 m0, 0x400
    v_mfma_f32_16x16x32_bf16 v[232:235], a[40:43], a[104:107], v[232:235]
    ds_read_b64_tr_b16 a[64:65], v24 offset:0
    ds_read_b64_tr_b16 a[66:67], v24 offset:512
    ds_read_b64_tr_b16 a[68:69], v25 offset:0
    ds_read_b64_tr_b16 a[70:71], v25 offset:512
    buffer_load_dwordx4 v14, s[16:19], s74 offen lds
    v_mfma_f32_16x16x32_bf16 v[236:239], a[44:47], a[104:107], v[236:239]
    ds_read_b64_tr_b16 a[72:73], v26 offset:0
    ds_read_b64_tr_b16 a[74:75], v26 offset:512
    ds_read_b64_tr_b16 a[76:77], v27 offset:0
    ds_read_b64_tr_b16 a[78:79], v27 offset:512
    s_addk_i32 m0, 0x400
    v_mfma_f32_16x16x32_bf16 v[240:243], a[32:35], a[108:111], v[240:243]
    ds_read_b128 a[16:19], v29 offset:24576
    ds_read_b128 a[20:23], v29 offset:26624
    ds_read_b128 a[24:27], v29 offset:8192
    ds_read_b128 a[28:31], v29 offset:10240
    buffer_load_dwordx4 v15, s[16:19], s74 offen lds
    v_mfma_f32_16x16x32_bf16 v[244:247], a[36:39], a[108:111], v[244:247]
    v_mfma_f32_16x16x32_bf16 v[248:251], a[40:43], a[108:111], v[248:251]
    v_mfma_f32_16x16x32_bf16 v[252:255], a[44:47], a[108:111], v[252:255]
    s_waitcnt lgkmcnt(0)
    v_mfma_f32_16x16x32_bf16 v[128:131], a[0:3], a[48:51], v[128:131]
    s_add_u32 m0, s42, 32768
    v_mfma_f32_16x16x32_bf16 v[132:135], a[4:7], a[48:51], v[132:135]
    s_add_u32 s74, s86, s65
    v_mfma_f32_16x16x32_bf16 a[128:131], v[64:67], a[192:195], 0
    v_mfma_f32_16x16x32_bf16 v[136:139], a[8:11], a[48:51], v[136:139]
    buffer_load_dwordx4 v12, s[16:19], s74 offen lds
    v_mfma_f32_16x16x32_bf16 v[140:143], a[12:15], a[48:51], v[140:143]
    s_addk_i32 m0, 0x400
    v_mfma_f32_16x16x32_bf16 a[132:135], v[72:75], a[192:195], 0
    v_mfma_f32_16x16x32_bf16 v[144:147], a[0:3], a[52:55], v[144:147]
    buffer_load_dwordx4 v13, s[16:19], s74 offen lds
    v_mfma_f32_16x16x32_bf16 v[148:151], a[4:7], a[52:55], v[148:151]
    s_addk_i32 m0, 0x400
    v_mfma_f32_16x16x32_bf16 a[136:139], v[80:83], a[192:195], 0
    v_mfma_f32_16x16x32_bf16 v[152:155], a[8:11], a[52:55], v[152:155]
    buffer_load_dwordx4 v14, s[16:19], s74 offen lds
    v_mfma_f32_16x16x32_bf16 v[156:159], a[12:15], a[52:55], v[156:159]
    s_addk_i32 m0, 0x400
    v_mfma_f32_16x16x32_bf16 a[140:143], v[88:91], a[192:195], 0
    v_mfma_f32_16x16x32_bf16 v[160:163], a[0:3], a[56:59], v[160:163]
    buffer_load_dwordx4 v15, s[16:19], s74 offen lds
    v_mfma_f32_16x16x32_bf16 v[164:167], a[4:7], a[56:59], v[164:167]
    s_add_u32 m0, s41, 16384
    v_mfma_f32_16x16x32_bf16 a[144:147], v[64:67], a[196:199], 0
    v_mfma_f32_16x16x32_bf16 v[168:171], a[8:11], a[56:59], v[168:171]
    s_add_u32 s88, s87, s69
    v_mfma_f32_16x16x32_bf16 v[172:175], a[12:15], a[56:59], v[172:175]
    s_mov_b32 s75, s88
    v_mfma_f32_16x16x32_bf16 a[148:151], v[72:75], a[196:199], 0
    v_mfma_f32_16x16x32_bf16 v[176:179], a[0:3], a[60:63], v[176:179]
    buffer_load_dwordx4 v16, s[20:23], s75 offen lds
    v_mfma_f32_16x16x32_bf16 v[180:183], a[4:7], a[60:63], v[180:183]
    s_addk_i32 m0, 0x400
    v_mfma_f32_16x16x32_bf16 a[152:155], v[80:83], a[196:199], 0
    v_mfma_f32_16x16x32_bf16 v[184:187], a[8:11], a[60:63], v[184:187]
    buffer_load_dwordx4 v17, s[20:23], s75 offen lds
    v_mfma_f32_16x16x32_bf16 v[188:191], a[12:15], a[60:63], v[188:191]
    v_mfma_f32_16x16x32_bf16 a[156:159], v[88:91], a[196:199], 0
    s_waitcnt vmcnt(10)
    s_addk_i32 m0, 0x400
    v_mfma_f32_16x16x32_bf16 v[192:195], a[0:3], a[64:67], v[192:195]
    ds_read_b64_tr_b16 a[80:81], v24 offset:16384
    buffer_load_dwordx4 v18, s[20:23], s75 offen lds
    v_mfma_f32_16x16x32_bf16 v[196:199], a[4:7], a[64:67], v[196:199]
    ds_read_b64_tr_b16 a[82:83], v24 offset:16896
    s_addk_i32 m0, 0x400
    v_mfma_f32_16x16x32_bf16 a[160:163], v[68:71], a[200:203], 0
    ds_read_b64_tr_b16 a[84:85], v25 offset:16384
    buffer_load_dwordx4 v19, s[20:23], s75 offen lds
    v_mfma_f32_16x16x32_bf16 v[200:203], a[8:11], a[64:67], v[200:203]
    ds_read_b64_tr_b16 a[86:87], v25 offset:16896
    v_mfma_f32_16x16x32_bf16 v[204:207], a[12:15], a[64:67], v[204:207]
    ds_read_b64_tr_b16 a[88:89], v26 offset:16384
    s_addk_i32 m0, 0x400
    v_mfma_f32_16x16x32_bf16 a[164:167], v[76:79], a[200:203], 0
    ds_read_b64_tr_b16 a[90:91], v26 offset:16896
    s_add_u32 s75, s88, 229376
    v_mfma_f32_16x16x32_bf16 v[208:211], a[0:3], a[68:71], v[208:211]
    ds_read_b64_tr_b16 a[92:93], v27 offset:16384
    buffer_load_dwordx4 v16, s[20:23], s75 offen lds
    v_mfma_f32_16x16x32_bf16 v[212:215], a[4:7], a[68:71], v[212:215]
    ds_read_b64_tr_b16 a[94:95], v27 offset:16896
    v_mfma_f32_16x16x32_bf16 a[168:171], v[84:87], a[200:203], 0
    ds_read_b64_tr_b16 a[96:97], v20 offset:0
    s_addk_i32 m0, 0x400
    v_mfma_f32_16x16x32_bf16 v[216:219], a[8:11], a[68:71], v[216:219]
    ds_read_b64_tr_b16 a[98:99], v20 offset:512
    buffer_load_dwordx4 v17, s[20:23], s75 offen lds
    v_mfma_f32_16x16x32_bf16 v[220:223], a[12:15], a[68:71], v[220:223]
    ds_read_b64_tr_b16 a[100:101], v21 offset:0
    s_addk_i32 m0, 0x400
    v_mfma_f32_16x16x32_bf16 a[172:175], v[92:95], a[200:203], 0
    ds_read_b64_tr_b16 a[102:103], v21 offset:512
    v_mfma_f32_16x16x32_bf16 v[224:227], a[0:3], a[72:75], v[224:227]
    ds_read_b64_tr_b16 a[104:105], v22 offset:0
    buffer_load_dwordx4 v18, s[20:23], s75 offen lds
    v_mfma_f32_16x16x32_bf16 v[228:231], a[4:7], a[72:75], v[228:231]
    ds_read_b64_tr_b16 a[106:107], v22 offset:512
    s_addk_i32 m0, 0x400
    v_mfma_f32_16x16x32_bf16 a[176:179], v[68:71], a[204:207], 0
    ds_read_b64_tr_b16 a[108:109], v23 offset:0
    buffer_load_dwordx4 v19, s[20:23], s75 offen lds
    v_mfma_f32_16x16x32_bf16 v[232:235], a[8:11], a[72:75], v[232:235]
    ds_read_b64_tr_b16 a[110:111], v23 offset:512
    v_mfma_f32_16x16x32_bf16 v[236:239], a[12:15], a[72:75], v[236:239]
    v_mfma_f32_16x16x32_bf16 a[180:183], v[76:79], a[204:207], 0
    v_mfma_f32_16x16x32_bf16 v[240:243], a[0:3], a[76:79], v[240:243]
    v_mfma_f32_16x16x32_bf16 v[244:247], a[4:7], a[76:79], v[244:247]
    v_mfma_f32_16x16x32_bf16 a[184:187], v[84:87], a[204:207], 0
    v_mfma_f32_16x16x32_bf16 v[248:251], a[8:11], a[76:79], v[248:251]
    v_mfma_f32_16x16x32_bf16 v[252:255], a[12:15], a[76:79], v[252:255]
    v_mfma_f32_16x16x32_bf16 a[188:191], v[92:95], a[204:207], 0
    s_waitcnt lgkmcnt(0)
    v_mfma_f32_16x16x32_bf16 v[128:131], a[16:19], a[80:83], v[128:131]
    s_addk_i32 m0, 0x400
    v_mfma_f32_16x16x32_bf16 v[132:135], a[20:23], a[80:83], v[132:135]
    s_add_u32 s75, s88, 28672
    v_mfma_f32_16x16x32_bf16 a[128:131], v[96:99], a[208:211], a[128:131]
    v_mfma_f32_16x16x32_bf16 v[136:139], a[24:27], a[80:83], v[136:139]
    buffer_load_dwordx4 v16, s[20:23], s75 offen lds
    v_mfma_f32_16x16x32_bf16 v[140:143], a[28:31], a[80:83], v[140:143]
    s_addk_i32 m0, 0x400
    v_mfma_f32_16x16x32_bf16 a[132:135], v[104:107], a[208:211], a[132:135]
    v_mfma_f32_16x16x32_bf16 v[144:147], a[16:19], a[84:87], v[144:147]
    buffer_load_dwordx4 v17, s[20:23], s75 offen lds
    v_mfma_f32_16x16x32_bf16 v[148:151], a[20:23], a[84:87], v[148:151]
    v_mfma_f32_16x16x32_bf16 a[136:139], v[112:115], a[208:211], a[136:139]
    s_addk_i32 m0, 0x400
    v_mfma_f32_16x16x32_bf16 v[152:155], a[24:27], a[84:87], v[152:155]
    buffer_load_dwordx4 v18, s[20:23], s75 offen lds
    v_mfma_f32_16x16x32_bf16 v[156:159], a[28:31], a[84:87], v[156:159]
    v_mfma_f32_16x16x32_bf16 a[140:143], v[120:123], a[208:211], a[140:143]
    s_addk_i32 m0, 0x400
    v_mfma_f32_16x16x32_bf16 v[160:163], a[16:19], a[88:91], v[160:163]
    v_mfma_f32_16x16x32_bf16 v[164:167], a[20:23], a[88:91], v[164:167]
    buffer_load_dwordx4 v19, s[20:23], s75 offen lds
    v_mfma_f32_16x16x32_bf16 a[144:147], v[96:99], a[212:215], a[144:147]
    s_add_u32 m0, s41, 8192
    v_mfma_f32_16x16x32_bf16 v[168:171], a[24:27], a[88:91], v[168:171]
    v_mfma_f32_16x16x32_bf16 v[172:175], a[28:31], a[88:91], v[172:175]
    s_add_u32 s75, s88, 258048
    v_mfma_f32_16x16x32_bf16 a[148:151], v[104:107], a[212:215], a[148:151]
    v_mfma_f32_16x16x32_bf16 v[176:179], a[16:19], a[92:95], v[176:179]
    buffer_load_dwordx4 v16, s[20:23], s75 offen lds
    v_mfma_f32_16x16x32_bf16 v[180:183], a[20:23], a[92:95], v[180:183]
    s_addk_i32 m0, 0x400
    v_mfma_f32_16x16x32_bf16 a[152:155], v[112:115], a[212:215], a[152:155]
    v_mfma_f32_16x16x32_bf16 v[184:187], a[24:27], a[92:95], v[184:187]
    buffer_load_dwordx4 v17, s[20:23], s75 offen lds
    v_mfma_f32_16x16x32_bf16 v[188:191], a[28:31], a[92:95], v[188:191]
    v_mfma_f32_16x16x32_bf16 a[156:159], v[120:123], a[212:215], a[156:159]
    s_waitcnt vmcnt(6)
    ds_read_b128 a[32:35], v28 offset:4096
    s_addk_i32 m0, 0x400
    v_mfma_f32_16x16x32_bf16 v[192:195], a[16:19], a[96:99], v[192:195]
    ds_read_b128 a[36:39], v28 offset:6144
    v_mfma_f32_16x16x32_bf16 v[196:199], a[20:23], a[96:99], v[196:199]
    ds_read_b128 a[40:43], v30 offset:32768
    ds_read_b128 a[44:47], v30 offset:34816
    v_mfma_f32_16x16x32_bf16 a[160:163], v[100:103], a[216:219], a[160:163]
    ds_read_b64_tr_b16 a[48:49], v20 offset:16384
    v_mfma_f32_16x16x32_bf16 v[200:203], a[24:27], a[96:99], v[200:203]
    ds_read_b64_tr_b16 a[50:51], v20 offset:16896
    ds_read_b64_tr_b16 a[52:53], v21 offset:16384
    buffer_load_dwordx4 v18, s[20:23], s75 offen lds
    v_mfma_f32_16x16x32_bf16 v[204:207], a[28:31], a[96:99], v[204:207]
    ds_read_b64_tr_b16 a[54:55], v21 offset:16896
    v_mfma_f32_16x16x32_bf16 a[164:167], v[108:111], a[216:219], a[164:167]
    ds_read_b64_tr_b16 a[56:57], v22 offset:16384
    ds_read_b64_tr_b16 a[58:59], v22 offset:16896
    v_mfma_f32_16x16x32_bf16 v[208:211], a[16:19], a[100:103], v[208:211]
    ds_read_b64_tr_b16 a[60:61], v23 offset:16384
    v_mfma_f32_16x16x32_bf16 v[212:215], a[20:23], a[100:103], v[212:215]
    ds_read_b64_tr_b16 a[62:63], v23 offset:16896
    ds_read_b64_tr_b16 a[64:65], v20 offset:20480
    s_addk_i32 m0, 0x400
    v_mfma_f32_16x16x32_bf16 a[168:171], v[116:119], a[216:219], a[168:171]
    ds_read_b64_tr_b16 a[66:67], v20 offset:20992
    v_mfma_f32_16x16x32_bf16 v[216:219], a[24:27], a[100:103], v[216:219]
    ds_read_b64_tr_b16 a[68:69], v21 offset:20480
    ds_read_b64_tr_b16 a[70:71], v21 offset:20992
    v_mfma_f32_16x16x32_bf16 v[220:223], a[28:31], a[100:103], v[220:223]
    ds_read_b64_tr_b16 a[72:73], v22 offset:20480
    v_mfma_f32_16x16x32_bf16 a[172:175], v[124:127], a[216:219], a[172:175]
    ds_read_b64_tr_b16 a[74:75], v22 offset:20992
    ds_read_b64_tr_b16 a[76:77], v23 offset:20480
    buffer_load_dwordx4 v19, s[20:23], s75 offen lds
    v_mfma_f32_16x16x32_bf16 v[224:227], a[16:19], a[104:107], v[224:227]
    ds_read_b64_tr_b16 a[78:79], v23 offset:20992
    v_mfma_f32_16x16x32_bf16 v[228:231], a[20:23], a[104:107], v[228:231]
    ds_read_b128 a[0:3], v29 offset:4096
    ds_read_b128 a[4:7], v29 offset:6144
    v_mfma_f32_16x16x32_bf16 a[176:179], v[100:103], a[220:223], a[176:179]
    ds_read_b128 a[8:11], v31 offset:32768
    v_mfma_f32_16x16x32_bf16 v[232:235], a[24:27], a[104:107], v[232:235]
    ds_read_b128 a[12:15], v31 offset:34816
    v_mfma_f32_16x16x32_bf16 v[236:239], a[28:31], a[104:107], v[236:239]
    v_mfma_f32_16x16x32_bf16 a[180:183], v[108:111], a[220:223], a[180:183]
    v_mfma_f32_16x16x32_bf16 v[240:243], a[16:19], a[108:111], v[240:243]
    v_mfma_f32_16x16x32_bf16 v[244:247], a[20:23], a[108:111], v[244:247]
    v_mfma_f32_16x16x32_bf16 a[184:187], v[116:119], a[220:223], a[184:187]
    v_mfma_f32_16x16x32_bf16 v[248:251], a[24:27], a[108:111], v[248:251]
    v_mfma_f32_16x16x32_bf16 v[252:255], a[28:31], a[108:111], v[252:255]
    v_mfma_f32_16x16x32_bf16 a[188:191], v[124:127], a[220:223], a[188:191]
    s_waitcnt lgkmcnt(0)
    v_mfma_f32_16x16x32_bf16 v[128:131], a[32:35], a[48:51], v[128:131]
    s_waitcnt vmcnt(0)
    v_mfma_f32_16x16x32_bf16 v[132:135], a[36:39], a[48:51], v[132:135]
    ds_read_b64_tr_b16 a[80:81], v20 offset:24576
    v_mfma_f32_16x16x32_bf16 v[136:139], a[40:43], a[48:51], v[136:139]
    ds_read_b64_tr_b16 a[82:83], v20 offset:25088
    v_mfma_f32_16x16x32_bf16 v[140:143], a[44:47], a[48:51], v[140:143]
    ds_read_b64_tr_b16 a[84:85], v21 offset:24576
    v_mfma_f32_16x16x32_bf16 v[144:147], a[32:35], a[52:55], v[144:147]
    v_mfma_f32_16x16x32_bf16 v[148:151], a[36:39], a[52:55], v[148:151]
    ds_read_b64_tr_b16 a[86:87], v21 offset:25088
    v_mfma_f32_16x16x32_bf16 v[152:155], a[40:43], a[52:55], v[152:155]
    ds_read_b64_tr_b16 a[88:89], v22 offset:24576
    v_mfma_f32_16x16x32_bf16 v[156:159], a[44:47], a[52:55], v[156:159]
    ds_read_b64_tr_b16 a[90:91], v22 offset:25088
    v_mfma_f32_16x16x32_bf16 v[160:163], a[32:35], a[56:59], v[160:163]
    v_mfma_f32_16x16x32_bf16 v[164:167], a[36:39], a[56:59], v[164:167]
    ds_read_b64_tr_b16 a[92:93], v23 offset:24576
    v_mfma_f32_16x16x32_bf16 v[168:171], a[40:43], a[56:59], v[168:171]
    ds_read_b64_tr_b16 a[94:95], v23 offset:25088
    v_mfma_f32_16x16x32_bf16 v[172:175], a[44:47], a[56:59], v[172:175]
    ds_read_b64_tr_b16 a[96:97], v20 offset:8192
    v_mfma_f32_16x16x32_bf16 v[176:179], a[32:35], a[60:63], v[176:179]
    ds_read_b64_tr_b16 a[98:99], v20 offset:8704
    v_mfma_f32_16x16x32_bf16 v[180:183], a[36:39], a[60:63], v[180:183]
    v_mfma_f32_16x16x32_bf16 v[184:187], a[40:43], a[60:63], v[184:187]
    ds_read_b64_tr_b16 a[100:101], v21 offset:8192
    v_mfma_f32_16x16x32_bf16 v[188:191], a[44:47], a[60:63], v[188:191]
    ds_read_b64_tr_b16 a[102:103], v21 offset:8704
    v_mfma_f32_16x16x32_bf16 v[192:195], a[32:35], a[64:67], v[192:195]
    ds_read_b64_tr_b16 a[104:105], v22 offset:8192
    v_mfma_f32_16x16x32_bf16 v[196:199], a[36:39], a[64:67], v[196:199]
    v_mfma_f32_16x16x32_bf16 v[200:203], a[40:43], a[64:67], v[200:203]
    ds_read_b64_tr_b16 a[106:107], v22 offset:8704
    v_mfma_f32_16x16x32_bf16 v[204:207], a[44:47], a[64:67], v[204:207]
    ds_read_b64_tr_b16 a[108:109], v23 offset:8192
    v_mfma_f32_16x16x32_bf16 v[208:211], a[32:35], a[68:71], v[208:211]
    ds_read_b64_tr_b16 a[110:111], v23 offset:8704
    v_mfma_f32_16x16x32_bf16 v[212:215], a[36:39], a[68:71], v[212:215]
    v_mfma_f32_16x16x32_bf16 v[216:219], a[40:43], a[68:71], v[216:219]
    v_mfma_f32_16x16x32_bf16 v[220:223], a[44:47], a[68:71], v[220:223]
    v_mfma_f32_16x16x32_bf16 v[224:227], a[32:35], a[72:75], v[224:227]
    v_mfma_f32_16x16x32_bf16 v[228:231], a[36:39], a[72:75], v[228:231]
    v_mfma_f32_16x16x32_bf16 v[232:235], a[40:43], a[72:75], v[232:235]
    v_mfma_f32_16x16x32_bf16 v[236:239], a[44:47], a[72:75], v[236:239]
    v_mfma_f32_16x16x32_bf16 v[240:243], a[32:35], a[76:79], v[240:243]
    v_mfma_f32_16x16x32_bf16 v[244:247], a[36:39], a[76:79], v[244:247]
    v_mfma_f32_16x16x32_bf16 v[248:251], a[40:43], a[76:79], v[248:251]
    v_mfma_f32_16x16x32_bf16 v[252:255], a[44:47], a[76:79], v[252:255]
    s_waitcnt lgkmcnt(0)
    s_cmp_eq_u32 s34, 1
    s_cbranch_scc1 L_tail1
    s_cmp_eq_u32 s34, 2
    s_cbranch_scc1 L_tail2
    s_cmp_eq_u32 s34, 3
    s_cbranch_scc1 L_tail3
    v_mfma_f32_16x16x32_bf16 v[136:139], a[8:11], a[80:83], v[136:139]
    v_mfma_f32_16x16x32_bf16 v[140:143], a[12:15], a[80:83], v[140:143]
    v_mfma_f32_16x16x32_bf16 v[152:155], a[8:11], a[84:87], v[152:155]
    v_mfma_f32_16x16x32_bf16 v[156:159], a[12:15], a[84:87], v[156:159]
    v_mfma_f32_16x16x32_bf16 v[168:171], a[8:11], a[88:91], v[168:171]
    v_mfma_f32_16x16x32_bf16 v[172:175], a[12:15], a[88:91], v[172:175]
    v_mfma_f32_16x16x32_bf16 v[184:187], a[8:11], a[92:95], v[184:187]
    v_mfma_f32_16x16x32_bf16 v[188:191], a[12:15], a[92:95], v[188:191]
    v_mfma_f32_16x16x32_bf16 v[200:203], a[8:11], a[96:99], v[200:203]
    v_mfma_f32_16x16x32_bf16 v[204:207], a[12:15], a[96:99], v[204:207]
    v_mfma_f32_16x16x32_bf16 v[216:219], a[8:11], a[100:103], v[216:219]
    v_mfma_f32_16x16x32_bf16 v[220:223], a[12:15], a[100:103], v[220:223]
    v_mfma_f32_16x16x32_bf16 v[232:235], a[8:11], a[104:107], v[232:235]
    v_mfma_f32_16x16x32_bf16 v[236:239], a[12:15], a[104:107], v[236:239]
    v_mfma_f32_16x16x32_bf16 v[248:251], a[8:11], a[108:111], v[248:251]
    v_mfma_f32_16x16x32_bf16 v[252:255], a[12:15], a[108:111], v[252:255]
    v_mfma_f32_16x16x32_bf16 v[128:131], a[0:3], a[80:83], v[128:131]
    v_cvt_pk_bf16_f32 v68, v136, v137
    v_cvt_pk_bf16_f32 v69, v138, v139
    v_mfma_f32_16x16x32_bf16 v[132:135], a[4:7], a[80:83], v[132:135]
    v_cvt_pk_bf16_f32 v70, v140, v141
    v_cvt_pk_bf16_f32 v71, v142, v143
    v_mfma_f32_16x16x32_bf16 v[144:147], a[0:3], a[84:87], v[144:147]
    v_cvt_pk_bf16_f32 v76, v152, v153
    v_cvt_pk_bf16_f32 v77, v154, v155
    v_mfma_f32_16x16x32_bf16 v[148:151], a[4:7], a[84:87], v[148:151]
    v_cvt_pk_bf16_f32 v78, v156, v157
    v_cvt_pk_bf16_f32 v79, v158, v159
    v_mfma_f32_16x16x32_bf16 v[160:163], a[0:3], a[88:91], v[160:163]
    v_cvt_pk_bf16_f32 v84, v168, v169
    v_cvt_pk_bf16_f32 v85, v170, v171
    v_mfma_f32_16x16x32_bf16 v[164:167], a[4:7], a[88:91], v[164:167]
    v_cvt_pk_bf16_f32 v86, v172, v173
    v_cvt_pk_bf16_f32 v87, v174, v175
    v_mfma_f32_16x16x32_bf16 v[176:179], a[0:3], a[92:95], v[176:179]
    v_cvt_pk_bf16_f32 v92, v184, v185
    v_cvt_pk_bf16_f32 v93, v186, v187
    v_mfma_f32_16x16x32_bf16 v[180:183], a[4:7], a[92:95], v[180:183]
    v_cvt_pk_bf16_f32 v94, v188, v189
    v_cvt_pk_bf16_f32 v95, v190, v191
    v_mfma_f32_16x16x32_bf16 v[192:195], a[0:3], a[96:99], v[192:195]
    v_cvt_pk_bf16_f32 v100, v200, v201
    v_cvt_pk_bf16_f32 v101, v202, v203
    v_mfma_f32_16x16x32_bf16 v[196:199], a[4:7], a[96:99], v[196:199]
    v_cvt_pk_bf16_f32 v102, v204, v205
    v_cvt_pk_bf16_f32 v103, v206, v207
    v_mfma_f32_16x16x32_bf16 v[208:211], a[0:3], a[100:103], v[208:211]
    v_cvt_pk_bf16_f32 v108, v216, v217
    v_cvt_pk_bf16_f32 v109, v218, v219
    v_mfma_f32_16x16x32_bf16 v[212:215], a[4:7], a[100:103], v[212:215]
    v_cvt_pk_bf16_f32 v110, v220, v221
    v_cvt_pk_bf16_f32 v111, v222, v223
    v_mfma_f32_16x16x32_bf16 v[224:227], a[0:3], a[104:107], v[224:227]
    v_cvt_pk_bf16_f32 v116, v232, v233
    v_cvt_pk_bf16_f32 v117, v234, v235
    v_mfma_f32_16x16x32_bf16 v[228:231], a[4:7], a[104:107], v[228:231]
    v_cvt_pk_bf16_f32 v118, v236, v237
    v_cvt_pk_bf16_f32 v119, v238, v239
    v_mfma_f32_16x16x32_bf16 v[240:243], a[0:3], a[108:111], v[240:243]
    v_cvt_pk_bf16_f32 v124, v248, v249
    v_cvt_pk_bf16_f32 v125, v250, v251
    v_mfma_f32_16x16x32_bf16 v[244:247], a[4:7], a[108:111], v[244:247]
    v_cvt_pk_bf16_f32 v126, v252, v253
    v_cvt_pk_bf16_f32 v127, v254, v255
    v_mfma_f32_16x16x32_bf16 a[160:163], v[68:71], a[232:235], a[160:163]
    v_cvt_pk_bf16_f32 v64, v128, v129
    v_cvt_pk_bf16_f32 v65, v130, v131
    v_mfma_f32_16x16x32_bf16 a[164:167], v[76:79], a[232:235], a[164:167]
    v_cvt_pk_bf16_f32 v66, v132, v133
    v_cvt_pk_bf16_f32 v67, v134, v135
    v_mfma_f32_16x16x32_bf16 a[168:171], v[84:87], a[232:235], a[168:171]
    v_cvt_pk_bf16_f32 v72, v144, v145
    v_cvt_pk_bf16_f32 v73, v146, v147
    v_mfma_f32_16x16x32_bf16 a[172:175], v[92:95], a[232:235], a[172:175]
    v_cvt_pk_bf16_f32 v74, v148, v149
    v_cvt_pk_bf16_f32 v75, v150, v151
    v_mfma_f32_16x16x32_bf16 a[160:163], v[100:103], a[248:251], a[160:163]
    v_cvt_pk_bf16_f32 v80, v160, v161
    v_cvt_pk_bf16_f32 v81, v162, v163
    v_mfma_f32_16x16x32_bf16 a[164:167], v[108:111], a[248:251], a[164:167]
    v_cvt_pk_bf16_f32 v82, v164, v165
    v_cvt_pk_bf16_f32 v83, v166, v167
    v_mfma_f32_16x16x32_bf16 a[168:171], v[116:119], a[248:251], a[168:171]
    v_cvt_pk_bf16_f32 v88, v176, v177
    v_cvt_pk_bf16_f32 v89, v178, v179
    v_mfma_f32_16x16x32_bf16 a[172:175], v[124:127], a[248:251], a[172:175]
    v_cvt_pk_bf16_f32 v90, v180, v181
    v_cvt_pk_bf16_f32 v91, v182, v183
    v_mfma_f32_16x16x32_bf16 a[176:179], v[68:71], a[236:239], a[176:179]
    v_cvt_pk_bf16_f32 v96, v192, v193
    v_cvt_pk_bf16_f32 v97, v194, v195
    v_mfma_f32_16x16x32_bf16 a[180:183], v[76:79], a[236:239], a[180:183]
    v_cvt_pk_bf16_f32 v98, v196, v197
    v_cvt_pk_bf16_f32 v99, v198, v199
    v_mfma_f32_16x16x32_bf16 a[184:187], v[84:87], a[236:239], a[184:187]
    v_cvt_pk_bf16_f32 v104, v208, v209
    v_cvt_pk_bf16_f32 v105, v210, v211
    v_mfma_f32_16x16x32_bf16 a[188:191], v[92:95], a[236:239], a[188:191]
    v_cvt_pk_bf16_f32 v106, v212, v213
    v_cvt_pk_bf16_f32 v107, v214, v215
    v_mfma_f32_16x16x32_bf16 a[176:179], v[100:103], a[252:255], a[176:179]
    v_cvt_pk_bf16_f32 v112, v224, v225
    v_cvt_pk_bf16_f32 v113, v226, v227
    v_mfma_f32_16x16x32_bf16 a[180:183], v[108:111], a[252:255], a[180:183]
    v_cvt_pk_bf16_f32 v114, v228, v229
    v_cvt_pk_bf16_f32 v115, v230, v231
    v_mfma_f32_16x16x32_bf16 a[184:187], v[116:119], a[252:255], a[184:187]
    v_cvt_pk_bf16_f32 v120, v240, v241
    v_cvt_pk_bf16_f32 v121, v242, v243
    v_mfma_f32_16x16x32_bf16 a[188:191], v[124:127], a[252:255], a[188:191]
    v_cvt_pk_bf16_f32 v122, v244, v245
    v_cvt_pk_bf16_f32 v123, v246, v247
    v_mfma_f32_16x16x32_bf16 a[144:147], v[64:67], a[228:231], a[144:147]
    v_mfma_f32_16x16x32_bf16 a[148:151], v[72:75], a[228:231], a[148:151]
    v_mfma_f32_16x16x32_bf16 a[152:155], v[80:83], a[228:231], a[152:155]
    v_mfma_f32_16x16x32_bf16 a[156:159], v[88:91], a[228:231], a[156:159]
    v_mfma_f32_16x16x32_bf16 a[144:147], v[96:99], a[244:247], a[144:147]
    ds_write_b128 v50, a[160:163] offset:8192
    v_mfma_f32_16x16x32_bf16 a[148:151], v[104:107], a[244:247], a[148:151]
    ds_write_b128 v50, a[164:167] offset:9216
    v_mfma_f32_16x16x32_bf16 a[152:155], v[112:115], a[244:247], a[152:155]
    ds_write_b128 v50, a[168:171] offset:10240
    v_mfma_f32_16x16x32_bf16 a[156:159], v[120:123], a[244:247], a[156:159]
    ds_write_b128 v50, a[172:175] offset:11264
    v_mfma_f32_16x16x32_bf16 a[128:131], v[64:67], a[224:227], a[128:131]
    ds_write_b128 v50, a[176:179] offset:12288
    v_mfma_f32_16x16x32_bf16 a[132:135], v[72:75], a[224:227], a[132:135]
    ds_write_b128 v50, a[180:183] offset:13312
    v_mfma_f32_16x16x32_bf16 a[136:139], v[80:83], a[224:227], a[136:139]
    ds_write_b128 v50, a[184:187] offset:14336
    v_mfma_f32_16x16x32_bf16 a[140:143], v[88:91], a[224:227], a[140:143]
    ds_write_b128 v50, a[188:191] offset:15360
    v_mfma_f32_16x16x32_bf16 a[128:131], v[96:99], a[240:243], a[128:131]
    v_mfma_f32_16x16x32_bf16 a[132:135], v[104:107], a[240:243], a[132:135]
    v_mfma_f32_16x16x32_bf16 a[136:139], v[112:115], a[240:243], a[136:139]
    v_mfma_f32_16x16x32_bf16 a[140:143], v[120:123], a[240:243], a[140:143]
    ds_write_b128 v50, a[144:147] offset:4096
    ds_write_b128 v50, a[148:151] offset:5120
    ds_write_b128 v50, a[152:155] offset:6144
    ds_write_b128 v50, a[156:159] offset:7168
    s_waitcnt lgkmcnt(0)
    s_barrier
    ds_read_b128 v[144:147], v51 offset:28672
    ds_read_b128 v[148:151], v51 offset:29696
    ds_read_b128 v[152:155], v51 offset:30720
    ds_read_b128 v[156:159], v51 offset:31744
    ds_read_b128 v[160:163], v52 offset:0
    ds_read_b128 v[164:167], v52 offset:1024
    ds_read_b128 v[168:171], v52 offset:2048
    ds_read_b128 v[172:175], v52 offset:3072
    ds_read_b128 v[176:179], v52 offset:28672
    ds_read_b128 v[180:183], v52 offset:29696
    ds_read_b128 v[184:187], v52 offset:30720
    ds_read_b128 v[188:191], v52 offset:31744
    v_accvgpr_read_b32 v128, a128
    v_accvgpr_read_b32 v129, a129
    v_accvgpr_read_b32 v130, a130
    v_accvgpr_read_b32 v131, a131
    v_accvgpr_read_b32 v132, a132
    v_accvgpr_read_b32 v133, a133
    v_accvgpr_read_b32 v134, a134
    v_accvgpr_read_b32 v135, a135
    v_accvgpr_read_b32 v136, a136
    v_accvgpr_read_b32 v137, a137
    v_accvgpr_read_b32 v138, a138
    v_accvgpr_read_b32 v139, a139
    v_accvgpr_read_b32 v140, a140
    v_accvgpr_read_b32 v141, a141
    v_accvgpr_read_b32 v142, a142
    v_accvgpr_read_b32 v143, a143
    s_waitcnt lgkmcnt(0)
    v_pk_add_f32 v[144:145], v[144:145], v[160:161]
    v_pk_add_f32 v[146:147], v[146:147], v[162:163]
    v_pk_add_f32 v[148:149], v[148:149], v[164:165]
    v_pk_add_f32 v[150:151], v[150:151], v[166:167]
    v_pk_add_f32 v[152:153], v[152:153], v[168:169]
    v_pk_add_f32 v[154:155], v[154:155], v[170:171]
    v_pk_add_f32 v[156:157], v[156:157], v[172:173]
    v_pk_add_f32 v[158:159], v[158:159], v[174:175]
    v_pk_add_f32 v[128:129], v[128:129], v[176:177]
    v_pk_add_f32 v[130:131], v[130:131], v[178:179]
    v_pk_add_f32 v[132:133], v[132:133], v[180:181]
    v_pk_add_f32 v[134:135], v[134:135], v[182:183]
    v_pk_add_f32 v[136:137], v[136:137], v[184:185]
    v_pk_add_f32 v[138:139], v[138:139], v[186:187]
    v_pk_add_f32 v[140:141], v[140:141], v[188:189]
    v_pk_add_f32 v[142:143], v[142:143], v[190:191]
    v_pk_add_f32 v[128:129], v[128:129], v[144:145]
    v_pk_add_f32 v[130:131], v[130:131], v[146:147]
    v_pk_add_f32 v[132:133], v[132:133], v[148:149]
    v_pk_add_f32 v[134:135], v[134:135], v[150:151]
    v_pk_add_f32 v[136:137], v[136:137], v[152:153]
    v_pk_add_f32 v[138:139], v[138:139], v[154:155]
    v_pk_add_f32 v[140:141], v[140:141], v[156:157]
    v_pk_add_f32 v[142:143], v[142:143], v[158:159]
    v_cvt_pk_bf16_f32 v32, v128, v129
    v_cvt_pk_bf16_f32 v33, v130, v131
    v_cvt_pk_bf16_f32 v34, v132, v133
    v_cvt_pk_bf16_f32 v35, v134, v135
    v_cvt_pk_bf16_f32 v36, v136, v137
    v_cvt_pk_bf16_f32 v37, v138, v139
    v_cvt_pk_bf16_f32 v38, v140, v141
    v_cvt_pk_bf16_f32 v39, v142, v143
    v_permlane16_swap_b32 v32, v34
    v_permlane16_swap_b32 v33, v35
    v_permlane16_swap_b32 v36, v38
    v_permlane16_swap_b32 v37, v39
    buffer_store_dwordx4 v[32:35], v49, s[28:31], s81 offen offset:0 nt
    buffer_store_dwordx4 v[36:39], v49, s[28:31], s81 offen offset:64 nt
    s_endpgm
L_tail1:
    v_mfma_f32_16x16x32_bf16 v[136:139], a[8:11], a[80:83], v[136:139]
    v_mfma_f32_16x16x32_bf16 v[140:143], a[12:15], a[80:83], v[140:143]
    v_mfma_f32_16x16x32_bf16 v[152:155], a[8:11], a[84:87], v[152:155]
    v_mfma_f32_16x16x32_bf16 v[156:159], a[12:15], a[84:87], v[156:159]
    v_mfma_f32_16x16x32_bf16 v[168:171], a[8:11], a[88:91], v[168:171]
    v_mfma_f32_16x16x32_bf16 v[172:175], a[12:15], a[88:91], v[172:175]
    v_mfma_f32_16x16x32_bf16 v[184:187], a[8:11], a[92:95], v[184:187]
    v_mfma_f32_16x16x32_bf16 v[188:191], a[12:15], a[92:95], v[188:191]
    v_mfma_f32_16x16x32_bf16 v[200:203], a[8:11], a[96:99], v[200:203]
    v_mfma_f32_16x16x32_bf16 v[204:207], a[12:15], a[96:99], v[204:207]
    v_mfma_f32_16x16x32_bf16 v[216:219], a[8:11], a[100:103], v[216:219]
    v_mfma_f32_16x16x32_bf16 v[220:223], a[12:15], a[100:103], v[220:223]
    v_mfma_f32_16x16x32_bf16 v[232:235], a[8:11], a[104:107], v[232:235]
    v_mfma_f32_16x16x32_bf16 v[236:239], a[12:15], a[104:107], v[236:239]
    v_mfma_f32_16x16x32_bf16 v[248:251], a[8:11], a[108:111], v[248:251]
    v_mfma_f32_16x16x32_bf16 v[252:255], a[12:15], a[108:111], v[252:255]
    v_mfma_f32_16x16x32_bf16 v[128:131], a[0:3], a[80:83], v[128:131]
    v_cvt_pk_bf16_f32 v68, v136, v137
    v_cvt_pk_bf16_f32 v69, v138, v139
    v_mfma_f32_16x16x32_bf16 v[132:135], a[4:7], a[80:83], v[132:135]
    v_cvt_pk_bf16_f32 v70, v140, v141
    v_cvt_pk_bf16_f32 v71, v142, v143
    v_mfma_f32_16x16x32_bf16 v[144:147], a[0:3], a[84:87], v[144:147]
    v_cvt_pk_bf16_f32 v76, v152, v153
    v_cvt_pk_bf16_f32 v77, v154, v155
    v_mfma_f32_16x16x32_bf16 v[148:151], a[4:7], a[84:87], v[148:151]
    v_cvt_pk_bf16_f32 v78, v156, v157
    v_cvt_pk_bf16_f32 v79, v158, v159
    v_mfma_f32_16x16x32_bf16 v[160:163], a[0:3], a[88:91], v[160:163]
    v_cvt_pk_bf16_f32 v84, v168, v169
    v_cvt_pk_bf16_f32 v85, v170, v171
    v_mfma_f32_16x16x32_bf16 v[164:167], a[4:7], a[88:91], v[164:167]
    v_cvt_pk_bf16_f32 v86, v172, v173
    v_cvt_pk_bf16_f32 v87, v174, v175
    v_mfma_f32_16x16x32_bf16 v[176:179], a[0:3], a[92:95], v[176:179]
    v_cvt_pk_bf16_f32 v92, v184, v185
    v_cvt_pk_bf16_f32 v93, v186, v187
    v_mfma_f32_16x16x32_bf16 v[180:183], a[4:7], a[92:95], v[180:183]
    v_cvt_pk_bf16_f32 v94, v188, v189
    v_cvt_pk_bf16_f32 v95, v190, v191
    v_mfma_f32_16x16x32_bf16 v[192:195], a[0:3], a[96:99], v[192:195]
    v_cvt_pk_bf16_f32 v100, v200, v201
    v_cvt_pk_bf16_f32 v101, v202, v203
    v_mfma_f32_16x16x32_bf16 v[196:199], a[4:7], a[96:99], v[196:199]
    v_cvt_pk_bf16_f32 v102, v204, v205
    v_cvt_pk_bf16_f32 v103, v206, v207
    v_mfma_f32_16x16x32_bf16 v[208:211], a[0:3], a[100:103], v[208:211]
    v_cvt_pk_bf16_f32 v108, v216, v217
    v_cvt_pk_bf16_f32 v109, v218, v219
    v_mfma_f32_16x16x32_bf16 v[212:215], a[4:7], a[100:103], v[212:215]
    v_cvt_pk_bf16_f32 v110, v220, v221
    v_cvt_pk_bf16_f32 v111, v222, v223
    v_mfma_f32_16x16x32_bf16 v[224:227], a[0:3], a[104:107], v[224:227]
    v_cvt_pk_bf16_f32 v116, v232, v233
    v_cvt_pk_bf16_f32 v117, v234, v235
    v_mfma_f32_16x16x32_bf16 v[228:231], a[4:7], a[104:107], v[228:231]
    v_cvt_pk_bf16_f32 v118, v236, v237
    v_cvt_pk_bf16_f32 v119, v238, v239
    v_mfma_f32_16x16x32_bf16 v[240:243], a[0:3], a[108:111], v[240:243]
    v_cvt_pk_bf16_f32 v124, v248, v249
    v_cvt_pk_bf16_f32 v125, v250, v251
    v_mfma_f32_16x16x32_bf16 v[244:247], a[4:7], a[108:111], v[244:247]
    v_cvt_pk_bf16_f32 v126, v252, v253
    v_cvt_pk_bf16_f32 v127, v254, v255
    v_mfma_f32_16x16x32_bf16 a[160:163], v[68:71], a[232:235], a[160:163]
    v_cvt_pk_bf16_f32 v64, v128, v129
    v_cvt_pk_bf16_f32 v65, v130, v131
    v_mfma_f32_16x16x32_bf16 a[164:167], v[76:79], a[232:235], a[164:167]
    v_cvt_pk_bf16_f32 v66, v132, v133
    v_cvt_pk_bf16_f32 v67, v134, v135
    v_mfma_f32_16x16x32_bf16 a[168:171], v[84:87], a[232:235], a[168:171]
    v_cvt_pk_bf16_f32 v72, v144, v145
    v_cvt_pk_bf16_f32 v73, v146, v147
    v_mfma_f32_16x16x32_bf16 a[172:175], v[92:95], a[232:235], a[172:175]
    v_cvt_pk_bf16_f32 v74, v148, v149
    v_cvt_pk_bf16_f32 v75, v150, v151
    v_mfma_f32_16x16x32_bf16 a[160:163], v[100:103], a[248:251], a[160:163]
    v_cvt_pk_bf16_f32 v80, v160, v161
    v_cvt_pk_bf16_f32 v81, v162, v163
    v_mfma_f32_16x16x32_bf16 a[164:167], v[108:111], a[248:251], a[164:167]
    v_cvt_pk_bf16_f32 v82, v164, v165
    v_cvt_pk_bf16_f32 v83, v166, v167
    v_mfma_f32_16x16x32_bf16 a[168:171], v[116:119], a[248:251], a[168:171]
    v_cvt_pk_bf16_f32 v88, v176, v177
    v_cvt_pk_bf16_f32 v89, v178, v179
    v_mfma_f32_16x16x32_bf16 a[172:175], v[124:127], a[248:251], a[172:175]
    v_cvt_pk_bf16_f32 v90, v180, v181
    v_cvt_pk_bf16_f32 v91, v182, v183
    v_mfma_f32_16x16x32_bf16 a[176:179], v[68:71], a[236:239], a[176:179]
    v_cvt_pk_bf16_f32 v96, v192, v193
    v_cvt_pk_bf16_f32 v97, v194, v195
    v_mfma_f32_16x16x32_bf16 a[180:183], v[76:79], a[236:239], a[180:183]
    v_cvt_pk_bf16_f32 v98, v196, v197
    v_cvt_pk_bf16_f32 v99, v198, v199
    v_mfma_f32_16x16x32_bf16 a[184:187], v[84:87], a[236:239], a[184:187]
    v_cvt_pk_bf16_f32 v104, v208, v209
    v_cvt_pk_bf16_f32 v105, v210, v211
    v_mfma_f32_16x16x32_bf16 a[188:191], v[92:95], a[236:239], a[188:191]
    v_cvt_pk_bf16_f32 v106, v212, v213
    v_cvt_pk_bf16_f32 v107, v214, v215
    v_mfma_f32_16x16x32_bf16 a[176:179], v[100:103], a[252:255], a[176:179]
    v_cvt_pk_bf16_f32 v112, v224, v225
    v_cvt_pk_bf16_f32 v113, v226, v227
    v_mfma_f32_16x16x32_bf16 a[180:183], v[108:111], a[252:255], a[180:183]
    v_cvt_pk_bf16_f32 v114, v228, v229
    v_cvt_pk_bf16_f32 v115, v230, v231
    v_mfma_f32_16x16x32_bf16 a[184:187], v[116:119], a[252:255], a[184:187]
    v_cvt_pk_bf16_f32 v120, v240, v241
    v_cvt_pk_bf16_f32 v121, v242, v243
    v_mfma_f32_16x16x32_bf16 a[188:191], v[124:127], a[252:255], a[188:191]
    v_cvt_pk_bf16_f32 v122, v244, v245
    v_cvt_pk_bf16_f32 v123, v246, v247
    v_mfma_f32_16x16x32_bf16 a[128:131], v[64:67], a[224:227], a[128:131]
    v_mfma_f32_16x16x32_bf16 a[132:135], v[72:75], a[224:227], a[132:135]
    v_mfma_f32_16x16x32_bf16 a[136:139], v[80:83], a[224:227], a[136:139]
    v_mfma_f32_16x16x32_bf16 a[140:143], v[88:91], a[224:227], a[140:143]
    v_mfma_f32_16x16x32_bf16 a[128:131], v[96:99], a[240:243], a[128:131]
    ds_write_b128 v50, a[160:163] offset:8192
    v_mfma_f32_16x16x32_bf16 a[132:135], v[104:107], a[240:243], a[132:135]
    ds_write_b128 v50, a[164:167] offset:9216
    v_mfma_f32_16x16x32_bf16 a[136:139], v[112:115], a[240:243], a[136:139]
    ds_write_b128 v50, a[168:171] offset:10240
    v_mfma_f32_16x16x32_bf16 a[140:143], v[120:123], a[240:243], a[140:143]
    ds_write_b128 v50, a[172:175] offset:11264
    v_mfma_f32_16x16x32_bf16 a[144:147], v[64:67], a[228:231], a[144:147]
    ds_write_b128 v50, a[176:179] offset:12288
    v_mfma_f32_16x16x32_bf16 a[148:151], v[72:75], a[228:231], a[148:151]
    ds_write_b128 v50, a[180:183] offset:13312
    v_mfma_f32_16x16x32_bf16 a[152:155], v[80:83], a[228:231], a[152:155]
    ds_write_b128 v50, a[184:187] offset:14336
    v_mfma_f32_16x16x32_bf16 a[156:159], v[88:91], a[228:231], a[156:159]
    ds_write_b128 v50, a[188:191] offset:15360
    v_mfma_f32_16x16x32_bf16 a[144:147], v[96:99], a[244:247], a[144:147]
    v_mfma_f32_16x16x32_bf16 a[148:151], v[104:107], a[244:247], a[148:151]
    v_mfma_f32_16x16x32_bf16 a[152:155], v[112:115], a[244:247], a[152:155]
    v_mfma_f32_16x16x32_bf16 a[156:159], v[120:123], a[244:247], a[156:159]
    ds_write_b128 v50, a[128:131] offset:0
    ds_write_b128 v50, a[132:135] offset:1024
    ds_write_b128 v50, a[136:139] offset:2048
    ds_write_b128 v50, a[140:143] offset:3072
    s_waitcnt lgkmcnt(0)
    s_barrier
    ds_read_b128 v[144:147], v51 offset:0
    ds_read_b128 v[148:151], v51 offset:1024
    ds_read_b128 v[152:155], v51 offset:2048
    ds_read_b128 v[156:159], v51 offset:3072
    ds_read_b128 v[160:163], v52 offset:0
    ds_read_b128 v[164:167], v52 offset:1024
    ds_read_b128 v[168:171], v52 offset:2048
    ds_read_b128 v[172:175], v52 offset:3072
    ds_read_b128 v[176:179], v52 offset:28672
    ds_read_b128 v[180:183], v52 offset:29696
    ds_read_b128 v[184:187], v52 offset:30720
    ds_read_b128 v[188:191], v52 offset:31744
    v_accvgpr_read_b32 v128, a144
    v_accvgpr_read_b32 v129, a145
    v_accvgpr_read_b32 v130, a146
    v_accvgpr_read_b32 v131, a147
    v_accvgpr_read_b32 v132, a148
    v_accvgpr_read_b32 v133, a149
    v_accvgpr_read_b32 v134, a150
    v_accvgpr_read_b32 v135, a151
    v_accvgpr_read_b32 v136, a152
    v_accvgpr_read_b32 v137, a153
    v_accvgpr_read_b32 v138, a154
    v_accvgpr_read_b32 v139, a155
    v_accvgpr_read_b32 v140, a156
    v_accvgpr_read_b32 v141, a157
    v_accvgpr_read_b32 v142, a158
    v_accvgpr_read_b32 v143, a159
    s_waitcnt lgkmcnt(0)
    v_pk_add_f32 v[144:145], v[144:145], v[160:161]
    v_pk_add_f32 v[146:147], v[146:147], v[162:163]
    v_pk_add_f32 v[148:149], v[148:149], v[164:165]
    v_pk_add_f32 v[150:151], v[150:151], v[166:167]
    v_pk_add_f32 v[152:153], v[152:153], v[168:169]
    v_pk_add_f32 v[154:155], v[154:155], v[170:171]
    v_pk_add_f32 v[156:157], v[156:157], v[172:173]
    v_pk_add_f32 v[158:159], v[158:159], v[174:175]
    v_pk_add_f32 v[128:129], v[128:129], v[176:177]
    v_pk_add_f32 v[130:131], v[130:131], v[178:179]
    v_pk_add_f32 v[132:133], v[132:133], v[180:181]
    v_pk_add_f32 v[134:135], v[134:135], v[182:183]
    v_pk_add_f32 v[136:137], v[136:137], v[184:185]
    v_pk_add_f32 v[138:139], v[138:139], v[186:187]
    v_pk_add_f32 v[140:141], v[140:141], v[188:189]
    v_pk_add_f32 v[142:143], v[142:143], v[190:191]
    v_pk_add_f32 v[128:129], v[128:129], v[144:145]
    v_pk_add_f32 v[130:131], v[130:131], v[146:147]
    v_pk_add_f32 v[132:133], v[132:133], v[148:149]
    v_pk_add_f32 v[134:135], v[134:135], v[150:151]
    v_pk_add_f32 v[136:137], v[136:137], v[152:153]
    v_pk_add_f32 v[138:139], v[138:139], v[154:155]
    v_pk_add_f32 v[140:141], v[140:141], v[156:157]
    v_pk_add_f32 v[142:143], v[142:143], v[158:159]
    v_cvt_pk_bf16_f32 v32, v128, v129
    v_cvt_pk_bf16_f32 v33, v130, v131
    v_cvt_pk_bf16_f32 v34, v132, v133
    v_cvt_pk_bf16_f32 v35, v134, v135
    v_cvt_pk_bf16_f32 v36, v136, v137
    v_cvt_pk_bf16_f32 v37, v138, v139
    v_cvt_pk_bf16_f32 v38, v140, v141
    v_cvt_pk_bf16_f32 v39, v142, v143
    v_permlane16_swap_b32 v32, v34
    v_permlane16_swap_b32 v33, v35
    v_permlane16_swap_b32 v36, v38
    v_permlane16_swap_b32 v37, v39
    buffer_store_dwordx4 v[32:35], v49, s[28:31], s81 offen offset:0 nt
    buffer_store_dwordx4 v[36:39], v49, s[28:31], s81 offen offset:64 nt
    s_endpgm
L_tail2:
    v_mfma_f32_16x16x32_bf16 v[128:131], a[0:3], a[80:83], v[128:131]
    v_mfma_f32_16x16x32_bf16 v[132:135], a[4:7], a[80:83], v[132:135]
    v_mfma_f32_16x16x32_bf16 v[144:147], a[0:3], a[84:87], v[144:147]
    v_mfma_f32_16x16x32_bf16 v[148:151], a[4:7], a[84:87], v[148:151]
    v_mfma_f32_16x16x32_bf16 v[160:163], a[0:3], a[88:91], v[160:163]
    v_mfma_f32_16x16x32_bf16 v[164:167], a[4:7], a[88:91], v[164:167]
    v_mfma_f32_16x16x32_bf16 v[176:179], a[0:3], a[92:95], v[176:179]
    v_mfma_f32_16x16x32_bf16 v[180:183], a[4:7], a[92:95], v[180:183]
    v_mfma_f32_16x16x32_bf16 v[192:195], a[0:3], a[96:99], v[192:195]
    v_mfma_f32_16x16x32_bf16 v[196:199], a[4:7], a[96:99], v[196:199]
    v_mfma_f32_16x16x32_bf16 v[208:211], a[0:3], a[100:103], v[208:211]
    v_mfma_f32_16x16x32_bf16 v[212:215], a[4:7], a[100:103], v[212:215]
    v_mfma_f32_16x16x32_bf16 v[224:227], a[0:3], a[104:107], v[224:227]
    v_mfma_f32_16x16x32_bf16 v[228:231], a[4:7], a[104:107], v[228:231]
    v_mfma_f32_16x16x32_bf16 v[240:243], a[0:3], a[108:111], v[240:243]
    v_mfma_f32_16x16x32_bf16 v[244:247], a[4:7], a[108:111], v[244:247]
    v_mfma_f32_16x16x32_bf16 v[136:139], a[8:11], a[80:83], v[136:139]
    v_cvt_pk_bf16_f32 v64, v128, v129
    v_cvt_pk_bf16_f32 v65, v130, v131
    v_mfma_f32_16x16x32_bf16 v[140:143], a[12:15], a[80:83], v[140:143]
    v_cvt_pk_bf16_f32 v66, v132, v133
    v_cvt_pk_bf16_f32 v67, v134, v135
    v_mfma_f32_16x16x32_bf16 v[152:155], a[8:11], a[84:87], v[152:155]
    v_cvt_pk_bf16_f32 v72, v144, v145
    v_cvt_pk_bf16_f32 v73, v146, v147
    v_mfma_f32_16x16x32_bf16 v[156:159], a[12:15], a[84:87], v[156:159]
    v_cvt_pk_bf16_f32 v74, v148, v149
    v_cvt_pk_bf16_f32 v75, v150, v151
    v_mfma_f32_16x16x32_bf16 v[168:171], a[8:11], a[88:91], v[168:171]
    v_cvt_pk_bf16_f32 v80, v160, v161
    v_cvt_pk_bf16_f32 v81, v162, v163
    v_mfma_f32_16x16x32_bf16 v[172:175], a[12:15], a[88:91], v[172:175]
    v_cvt_pk_bf16_f32 v82, v164, v165
    v_cvt_pk_bf16_f32 v83, v166, v167
    v_mfma_f32_16x16x32_bf16 v[184:187], a[8:11], a[92:95], v[184:187]
    v_cvt_pk_bf16_f32 v88, v176, v177
    v_cvt_pk_bf16_f32 v89, v178, v179
    v_mfma_f32_16x16x32_bf16 v[188:191], a[12:15], a[92:95], v[188:191]
    v_cvt_pk_bf16_f32 v90, v180, v181
    v_cvt_pk_bf16_f32 v91, v182, v183
    v_mfma_f32_16x16x32_bf16 v[200:203], a[8:11], a[96:99], v[200:203]
    v_cvt_pk_bf16_f32 v96, v192, v193
    v_cvt_pk_bf16_f32 v97, v194, v195
    v_mfma_f32_16x16x32_bf16 v[204:207], a[12:15], a[96:99], v[204:207]
    v_cvt_pk_bf16_f32 v98, v196, v197
    v_cvt_pk_bf16_f32 v99, v198, v199
    v_mfma_f32_16x16x32_bf16 v[216:219], a[8:11], a[100:103], v[216:219]
    v_cvt_pk_bf16_f32 v104, v208, v209
    v_cvt_pk_bf16_f32 v105, v210, v211
    v_mfma_f32_16x16x32_bf16 v[220:223], a[12:15], a[100:103], v[220:223]
    v_cvt_pk_bf16_f32 v106, v212, v213
    v_cvt_pk_bf16_f32 v107, v214, v215
    v_mfma_f32_16x16x32_bf16 v[232:235], a[8:11], a[104:107], v[232:235]
    v_cvt_pk_bf16_f32 v112, v224, v225
    v_cvt_pk_bf16_f32 v113, v226, v227
    v_mfma_f32_16x16x32_bf16 v[236:239], a[12:15], a[104:107], v[236:239]
    v_cvt_pk_bf16_f32 v114, v228, v229
    v_cvt_pk_bf16_f32 v115, v230, v231
    v_mfma_f32_16x16x32_bf16 v[248:251], a[8:11], a[108:111], v[248:251]
    v_cvt_pk_bf16_f32 v120, v240, v241
    v_cvt_pk_bf16_f32 v121, v242, v243
    v_mfma_f32_16x16x32_bf16 v[252:255], a[12:15], a[108:111], v[252:255]
    v_cvt_pk_bf16_f32 v122, v244, v245
    v_cvt_pk_bf16_f32 v123, v246, v247
    v_mfma_f32_16x16x32_bf16 a[128:131], v[64:67], a[224:227], a[128:131]
    v_cvt_pk_bf16_f32 v68, v136, v137
    v_cvt_pk_bf16_f32 v69, v138, v139
    v_mfma_f32_16x16x32_bf16 a[132:135], v[72:75], a[224:227], a[132:135]
    v_cvt_pk_bf16_f32 v70, v140, v141
    v_cvt_pk_bf16_f32 v71, v142, v143
    v_mfma_f32_16x16x32_bf16 a[136:139], v[80:83], a[224:227], a[136:139]
    v_cvt_pk_bf16_f32 v76, v152, v153
    v_cvt_pk_bf16_f32 v77, v154, v155
    v_mfma_f32_16x16x32_bf16 a[140:143], v[88:91], a[224:227], a[140:143]
    v_cvt_pk_bf16_f32 v78, v156, v157
    v_cvt_pk_bf16_f32 v79, v158, v159
    v_mfma_f32_16x16x32_bf16 a[128:131], v[96:99], a[240:243], a[128:131]
    v_cvt_pk_bf16_f32 v84, v168, v169
    v_cvt_pk_bf16_f32 v85, v170, v171
    v_mfma_f32_16x16x32_bf16 a[132:135], v[104:107], a[240:243], a[132:135]
    v_cvt_pk_bf16_f32 v86, v172, v173
    v_cvt_pk_bf16_f32 v87, v174, v175
    v_mfma_f32_16x16x32_bf16 a[136:139], v[112:115], a[240:243], a[136:139]
    v_cvt_pk_bf16_f32 v92, v184, v185
    v_cvt_pk_bf16_f32 v93, v186, v187
    v_mfma_f32_16x16x32_bf16 a[140:143], v[120:123], a[240:243], a[140:143]
    v_cvt_pk_bf16_f32 v94, v188, v189
    v_cvt_pk_bf16_f32 v95, v190, v191
    v_mfma_f32_16x16x32_bf16 a[144:147], v[64:67], a[228:231], a[144:147]
    v_cvt_pk_bf16_f32 v100, v200, v201
    v_cvt_pk_bf16_f32 v101, v202, v203
    v_mfma_f32_16x16x32_bf16 a[148:151], v[72:75], a[228:231], a[148:151]
    v_cvt_pk_bf16_f32 v102, v204, v205
    v_cvt_pk_bf16_f32 v103, v206, v207
    v_mfma_f32_16x16x32_bf16 a[152:155], v[80:83], a[228:231], a[152:155]
    v_cvt_pk_bf16_f32 v108, v216, v217
    v_cvt_pk_bf16_f32 v109, v218, v219
    v_mfma_f32_16x16x32_bf16 a[156:159], v[88:91], a[228:231], a[156:159]
    v_cvt_pk_bf16_f32 v110, v220, v221
    v_cvt_pk_bf16_f32 v111, v222, v223
    v_mfma_f32_16x16x32_bf16 a[144:147], v[96:99], a[244:247], a[144:147]
    v_cvt_pk_bf16_f32 v116, v232, v233
    v_cvt_pk_bf16_f32 v117, v234, v235
    v_mfma_f32_16x16x32_bf16 a[148:151], v[104:107], a[244:247], a[148:151]
    v_cvt_pk_bf16_f32 v118, v236, v237
    v_cvt_pk_bf16_f32 v119, v238, v239
    v_mfma_f32_16x16x32_bf16 a[152:155], v[112:115], a[244:247], a[152:155]
    v_cvt_pk_bf16_f32 v124, v248, v249
    v_cvt_pk_bf16_f32 v125, v250, v251
    v_mfma_f32_16x16x32_bf16 a[156:159], v[120:123], a[244:247], a[156:159]
    v_cvt_pk_bf16_f32 v126, v252, v253
    v_cvt_pk_bf16_f32 v127, v254, v255
    v_mfma_f32_16x16x32_bf16 a[176:179], v[68:71], a[236:239], a[176:179]
    v_mfma_f32_16x16x32_bf16 a[180:183], v[76:79], a[236:239], a[180:183]
    v_mfma_f32_16x16x32_bf16 a[184:187], v[84:87], a[236:239], a[184:187]
    v_mfma_f32_16x16x32_bf16 a[188:191], v[92:95], a[236:239], a[188:191]
    v_mfma_f32_16x16x32_bf16 a[176:179], v[100:103], a[252:255], a[176:179]
    ds_write_b128 v50, a[128:131] offset:0
    v_mfma_f32_16x16x32_bf16 a[180:183], v[108:111], a[252:255], a[180:183]
    ds_write_b128 v50, a[132:135] offset:1024
    v_mfma_f32_16x16x32_bf16 a[184:187], v[116:119], a[252:255], a[184:187]
    ds_write_b128 v50, a[136:139] offset:2048
    v_mfma_f32_16x16x32_bf16 a[188:191], v[124:127], a[252:255], a[188:191]
    ds_write_b128 v50, a[140:143] offset:3072
    v_mfma_f32_16x16x32_bf16 a[160:163], v[68:71], a[232:235], a[160:163]
    ds_write_b128 v50, a[144:147] offset:4096
    v_mfma_f32_16x16x32_bf16 a[164:167], v[76:79], a[232:235], a[164:167]
    ds_write_b128 v50, a[148:151] offset:5120
    v_mfma_f32_16x16x32_bf16 a[168:171], v[84:87], a[232:235], a[168:171]
    ds_write_b128 v50, a[152:155] offset:6144
    v_mfma_f32_16x16x32_bf16 a[172:175], v[92:95], a[232:235], a[172:175]
    ds_write_b128 v50, a[156:159] offset:7168
    v_mfma_f32_16x16x32_bf16 a[160:163], v[100:103], a[248:251], a[160:163]
    v_mfma_f32_16x16x32_bf16 a[164:167], v[108:111], a[248:251], a[164:167]
    v_mfma_f32_16x16x32_bf16 a[168:171], v[116:119], a[248:251], a[168:171]
    v_mfma_f32_16x16x32_bf16 a[172:175], v[124:127], a[248:251], a[172:175]
    ds_write_b128 v50, a[176:179] offset:12288
    ds_write_b128 v50, a[180:183] offset:13312
    ds_write_b128 v50, a[184:187] offset:14336
    ds_write_b128 v50, a[188:191] offset:15360
    s_waitcnt lgkmcnt(0)
    s_barrier
    ds_read_b128 v[144:147], v51 offset:0
    ds_read_b128 v[148:151], v51 offset:1024
    ds_read_b128 v[152:155], v51 offset:2048
    ds_read_b128 v[156:159], v51 offset:3072
    ds_read_b128 v[160:163], v51 offset:28672
    ds_read_b128 v[164:167], v51 offset:29696
    ds_read_b128 v[168:171], v51 offset:30720
    ds_read_b128 v[172:175], v51 offset:31744
    ds_read_b128 v[176:179], v52 offset:28672
    ds_read_b128 v[180:183], v52 offset:29696
    ds_read_b128 v[184:187], v52 offset:30720
    ds_read_b128 v[188:191], v52 offset:31744
    v_accvgpr_read_b32 v128, a160
    v_accvgpr_read_b32 v129, a161
    v_accvgpr_read_b32 v130, a162
    v_accvgpr_read_b32 v131, a163
    v_accvgpr_read_b32 v132, a164
    v_accvgpr_read_b32 v133, a165
    v_accvgpr_read_b32 v134, a166
    v_accvgpr_read_b32 v135, a167
    v_accvgpr_read_b32 v136, a168
    v_accvgpr_read_b32 v137, a169
    v_accvgpr_read_b32 v138, a170
    v_accvgpr_read_b32 v139, a171
    v_accvgpr_read_b32 v140, a172
    v_accvgpr_read_b32 v141, a173
    v_accvgpr_read_b32 v142, a174
    v_accvgpr_read_b32 v143, a175
    s_waitcnt lgkmcnt(0)
    v_pk_add_f32 v[144:145], v[144:145], v[160:161]
    v_pk_add_f32 v[146:147], v[146:147], v[162:163]
    v_pk_add_f32 v[148:149], v[148:149], v[164:165]
    v_pk_add_f32 v[150:151], v[150:151], v[166:167]
    v_pk_add_f32 v[152:153], v[152:153], v[168:169]
    v_pk_add_f32 v[154:155], v[154:155], v[170:171]
    v_pk_add_f32 v[156:157], v[156:157], v[172:173]
    v_pk_add_f32 v[158:159], v[158:159], v[174:175]
    v_pk_add_f32 v[128:129], v[128:129], v[176:177]
    v_pk_add_f32 v[130:131], v[130:131], v[178:179]
    v_pk_add_f32 v[132:133], v[132:133], v[180:181]
    v_pk_add_f32 v[134:135], v[134:135], v[182:183]
    v_pk_add_f32 v[136:137], v[136:137], v[184:185]
    v_pk_add_f32 v[138:139], v[138:139], v[186:187]
    v_pk_add_f32 v[140:141], v[140:141], v[188:189]
    v_pk_add_f32 v[142:143], v[142:143], v[190:191]
    v_pk_add_f32 v[128:129], v[128:129], v[144:145]
    v_pk_add_f32 v[130:131], v[130:131], v[146:147]
    v_pk_add_f32 v[132:133], v[132:133], v[148:149]
    v_pk_add_f32 v[134:135], v[134:135], v[150:151]
    v_pk_add_f32 v[136:137], v[136:137], v[152:153]
    v_pk_add_f32 v[138:139], v[138:139], v[154:155]
    v_pk_add_f32 v[140:141], v[140:141], v[156:157]
    v_pk_add_f32 v[142:143], v[142:143], v[158:159]
    v_cvt_pk_bf16_f32 v32, v128, v129
    v_cvt_pk_bf16_f32 v33, v130, v131
    v_cvt_pk_bf16_f32 v34, v132, v133
    v_cvt_pk_bf16_f32 v35, v134, v135
    v_cvt_pk_bf16_f32 v36, v136, v137
    v_cvt_pk_bf16_f32 v37, v138, v139
    v_cvt_pk_bf16_f32 v38, v140, v141
    v_cvt_pk_bf16_f32 v39, v142, v143
    v_permlane16_swap_b32 v32, v34
    v_permlane16_swap_b32 v33, v35
    v_permlane16_swap_b32 v36, v38
    v_permlane16_swap_b32 v37, v39
    buffer_store_dwordx4 v[32:35], v49, s[28:31], s81 offen offset:0 nt
    buffer_store_dwordx4 v[36:39], v49, s[28:31], s81 offen offset:64 nt
    s_endpgm
L_tail3:
    v_mfma_f32_16x16x32_bf16 v[128:131], a[0:3], a[80:83], v[128:131]
    v_mfma_f32_16x16x32_bf16 v[132:135], a[4:7], a[80:83], v[132:135]
    v_mfma_f32_16x16x32_bf16 v[144:147], a[0:3], a[84:87], v[144:147]
    v_mfma_f32_16x16x32_bf16 v[148:151], a[4:7], a[84:87], v[148:151]
    v_mfma_f32_16x16x32_bf16 v[160:163], a[0:3], a[88:91], v[160:163]
    v_mfma_f32_16x16x32_bf16 v[164:167], a[4:7], a[88:91], v[164:167]
    v_mfma_f32_16x16x32_bf16 v[176:179], a[0:3], a[92:95], v[176:179]
    v_mfma_f32_16x16x32_bf16 v[180:183], a[4:7], a[92:95], v[180:183]
    v_mfma_f32_16x16x32_bf16 v[192:195], a[0:3], a[96:99], v[192:195]
    v_mfma_f32_16x16x32_bf16 v[196:199], a[4:7], a[96:99], v[196:199]
    v_mfma_f32_16x16x32_bf16 v[208:211], a[0:3], a[100:103], v[208:211]
    v_mfma_f32_16x16x32_bf16 v[212:215], a[4:7], a[100:103], v[212:215]
    v_mfma_f32_16x16x32_bf16 v[224:227], a[0:3], a[104:107], v[224:227]
    v_mfma_f32_16x16x32_bf16 v[228:231], a[4:7], a[104:107], v[228:231]
    v_mfma_f32_16x16x32_bf16 v[240:243], a[0:3], a[108:111], v[240:243]
    v_mfma_f32_16x16x32_bf16 v[244:247], a[4:7], a[108:111], v[244:247]
    v_mfma_f32_16x16x32_bf16 v[136:139], a[8:11], a[80:83], v[136:139]
    v_cvt_pk_bf16_f32 v64, v128, v129
    v_cvt_pk_bf16_f32 v65, v130, v131
    v_mfma_f32_16x16x32_bf16 v[140:143], a[12:15], a[80:83], v[140:143]
    v_cvt_pk_bf16_f32 v66, v132, v133
    v_cvt_pk_bf16_f32 v67, v134, v135
    v_mfma_f32_16x16x32_bf16 v[152:155], a[8:11], a[84:87], v[152:155]
    v_cvt_pk_bf16_f32 v72, v144, v145
    v_cvt_pk_bf16_f32 v73, v146, v147
    v_mfma_f32_16x16x32_bf16 v[156:159], a[12:15], a[84:87], v[156:159]
    v_cvt_pk_bf16_f32 v74, v148, v149
    v_cvt_pk_bf16_f32 v75, v150, v151
    v_mfma_f32_16x16x32_bf16 v[168:171], a[8:11], a[88:91], v[168:171]
    v_cvt_pk_bf16_f32 v80, v160, v161
    v_cvt_pk_bf16_f32 v81, v162, v163
    v_mfma_f32_16x16x32_bf16 v[172:175], a[12:15], a[88:91], v[172:175]
    v_cvt_pk_bf16_f32 v82, v164, v165
    v_cvt_pk_bf16_f32 v83, v166, v167
    v_mfma_f32_16x16x32_bf16 v[184:187], a[8:11], a[92:95], v[184:187]
    v_cvt_pk_bf16_f32 v88, v176, v177
    v_cvt_pk_bf16_f32 v89, v178, v179
    v_mfma_f32_16x16x32_bf16 v[188:191], a[12:15], a[92:95], v[188:191]
    v_cvt_pk_bf16_f32 v90, v180, v181
    v_cvt_pk_bf16_f32 v91, v182, v183
    v_mfma_f32_16x16x32_bf16 v[200:203], a[8:11], a[96:99], v[200:203]
    v_cvt_pk_bf16_f32 v96, v192, v193
    v_cvt_pk_bf16_f32 v97, v194, v195
    v_mfma_f32_16x16x32_bf16 v[204:207], a[12:15], a[96:99], v[204:207]
    v_cvt_pk_bf16_f32 v98, v196, v197
    v_cvt_pk_bf16_f32 v99, v198, v199
    v_mfma_f32_16x16x32_bf16 v[216:219], a[8:11], a[100:103], v[216:219]
    v_cvt_pk_bf16_f32 v104, v208, v209
    v_cvt_pk_bf16_f32 v105, v210, v211
    v_mfma_f32_16x16x32_bf16 v[220:223], a[12:15], a[100:103], v[220:223]
    v_cvt_pk_bf16_f32 v106, v212, v213
    v_cvt_pk_bf16_f32 v107, v214, v215
    v_mfma_f32_16x16x32_bf16 v[232:235], a[8:11], a[104:107], v[232:235]
    v_cvt_pk_bf16_f32 v112, v224, v225
    v_cvt_pk_bf16_f32 v113, v226, v227
    v_mfma_f32_16x16x32_bf16 v[236:239], a[12:15], a[104:107], v[236:239]
    v_cvt_pk_bf16_f32 v114, v228, v229
    v_cvt_pk_bf16_f32 v115, v230, v231
    v_mfma_f32_16x16x32_bf16 v[248:251], a[8:11], a[108:111], v[248:251]
    v_cvt_pk_bf16_f32 v120, v240, v241
    v_cvt_pk_bf16_f32 v121, v242, v243
    v_mfma_f32_16x16x32_bf16 v[252:255], a[12:15], a[108:111], v[252:255]
    v_cvt_pk_bf16_f32 v122, v244, v245
    v_cvt_pk_bf16_f32 v123, v246, v247
    v_mfma_f32_16x16x32_bf16 a[128:131], v[64:67], a[224:227], a[128:131]
    v_cvt_pk_bf16_f32 v68, v136, v137
    v_cvt_pk_bf16_f32 v69, v138, v139
    v_mfma_f32_16x16x32_bf16 a[132:135], v[72:75], a[224:227], a[132:135]
    v_cvt_pk_bf16_f32 v70, v140, v141
    v_cvt_pk_bf16_f32 v71, v142, v143
    v_mfma_f32_16x16x32_bf16 a[136:139], v[80:83], a[224:227], a[136:139]
    v_cvt_pk_bf16_f32 v76, v152, v153
    v_cvt_pk_bf16_f32 v77, v154, v155
    v_mfma_f32_16x16x32_bf16 a[140:143], v[88:91], a[224:227], a[140:143]
    v_cvt_pk_bf16_f32 v78, v156, v157
    v_cvt_pk_bf16_f32 v79, v158, v159
    v_mfma_f32_16x16x32_bf16 a[128:131], v[96:99], a[240:243], a[128:131]
    v_cvt_pk_bf16_f32 v84, v168, v169
    v_cvt_pk_bf16_f32 v85, v170, v171
    v_mfma_f32_16x16x32_bf16 a[132:135], v[104:107], a[240:243], a[132:135]
    v_cvt_pk_bf16_f32 v86, v172, v173
    v_cvt_pk_bf16_f32 v87, v174, v175
    v_mfma_f32_16x16x32_bf16 a[136:139], v[112:115], a[240:243], a[136:139]
    v_cvt_pk_bf16_f32 v92, v184, v185
    v_cvt_pk_bf16_f32 v93, v186, v187
    v_mfma_f32_16x16x32_bf16 a[140:143], v[120:123], a[240:243], a[140:143]
    v_cvt_pk_bf16_f32 v94, v188, v189
    v_cvt_pk_bf16_f32 v95, v190, v191
    v_mfma_f32_16x16x32_bf16 a[144:147], v[64:67], a[228:231], a[144:147]
    v_cvt_pk_bf16_f32 v100, v200, v201
    v_cvt_pk_bf16_f32 v101, v202, v203
    v_mfma_f32_16x16x32_bf16 a[148:151], v[72:75], a[228:231], a[148:151]
    v_cvt_pk_bf16_f32 v102, v204, v205
    v_cvt_pk_bf16_f32 v103, v206, v207
    v_mfma_f32_16x16x32_bf16 a[152:155], v[80:83], a[228:231], a[152:155]
    v_cvt_pk_bf16_f32 v108, v216, v217
    v_cvt_pk_bf16_f32 v109, v218, v219
    v_mfma_f32_16x16x32_bf16 a[156:159], v[88:91], a[228:231], a[156:159]
    v_cvt_pk_bf16_f32 v110, v220, v221
    v_cvt_pk_bf16_f32 v111, v222, v223
    v_mfma_f32_16x16x32_bf16 a[144:147], v[96:99], a[244:247], a[144:147]
    v_cvt_pk_bf16_f32 v116, v232, v233
    v_cvt_pk_bf16_f32 v117, v234, v235
    v_mfma_f32_16x16x32_bf16 a[148:151], v[104:107], a[244:247], a[148:151]
    v_cvt_pk_bf16_f32 v118, v236, v237
    v_cvt_pk_bf16_f32 v119, v238, v239
    v_mfma_f32_16x16x32_bf16 a[152:155], v[112:115], a[244:247], a[152:155]
    v_cvt_pk_bf16_f32 v124, v248, v249
    v_cvt_pk_bf16_f32 v125, v250, v251
    v_mfma_f32_16x16x32_bf16 a[156:159], v[120:123], a[244:247], a[156:159]
    v_cvt_pk_bf16_f32 v126, v252, v253
    v_cvt_pk_bf16_f32 v127, v254, v255
    v_mfma_f32_16x16x32_bf16 a[160:163], v[68:71], a[232:235], a[160:163]
    v_mfma_f32_16x16x32_bf16 a[164:167], v[76:79], a[232:235], a[164:167]
    v_mfma_f32_16x16x32_bf16 a[168:171], v[84:87], a[232:235], a[168:171]
    v_mfma_f32_16x16x32_bf16 a[172:175], v[92:95], a[232:235], a[172:175]
    v_mfma_f32_16x16x32_bf16 a[160:163], v[100:103], a[248:251], a[160:163]
    ds_write_b128 v50, a[128:131] offset:0
    v_mfma_f32_16x16x32_bf16 a[164:167], v[108:111], a[248:251], a[164:167]
    ds_write_b128 v50, a[132:135] offset:1024
    v_mfma_f32_16x16x32_bf16 a[168:171], v[116:119], a[248:251], a[168:171]
    ds_write_b128 v50, a[136:139] offset:2048
    v_mfma_f32_16x16x32_bf16 a[172:175], v[124:127], a[248:251], a[172:175]
    ds_write_b128 v50, a[140:143] offset:3072
    v_mfma_f32_16x16x32_bf16 a[176:179], v[68:71], a[236:239], a[176:179]
    ds_write_b128 v50, a[144:147] offset:4096
    v_mfma_f32_16x16x32_bf16 a[180:183], v[76:79], a[236:239], a[180:183]
    ds_write_b128 v50, a[148:151] offset:5120
    v_mfma_f32_16x16x32_bf16 a[184:187], v[84:87], a[236:239], a[184:187]
    ds_write_b128 v50, a[152:155] offset:6144
    v_mfma_f32_16x16x32_bf16 a[188:191], v[92:95], a[236:239], a[188:191]
    ds_write_b128 v50, a[156:159] offset:7168
    v_mfma_f32_16x16x32_bf16 a[176:179], v[100:103], a[252:255], a[176:179]
    v_mfma_f32_16x16x32_bf16 a[180:183], v[108:111], a[252:255], a[180:183]
    v_mfma_f32_16x16x32_bf16 a[184:187], v[116:119], a[252:255], a[184:187]
    v_mfma_f32_16x16x32_bf16 a[188:191], v[124:127], a[252:255], a[188:191]
    ds_write_b128 v50, a[160:163] offset:8192
    ds_write_b128 v50, a[164:167] offset:9216
    ds_write_b128 v50, a[168:171] offset:10240
    ds_write_b128 v50, a[172:175] offset:11264
    s_waitcnt lgkmcnt(0)
    s_barrier
    ds_read_b128 v[144:147], v51 offset:0
    ds_read_b128 v[148:151], v51 offset:1024
    ds_read_b128 v[152:155], v51 offset:2048
    ds_read_b128 v[156:159], v51 offset:3072
    ds_read_b128 v[160:163], v51 offset:28672
    ds_read_b128 v[164:167], v51 offset:29696
    ds_read_b128 v[168:171], v51 offset:30720
    ds_read_b128 v[172:175], v51 offset:31744
    ds_read_b128 v[176:179], v52 offset:0
    ds_read_b128 v[180:183], v52 offset:1024
    ds_read_b128 v[184:187], v52 offset:2048
    ds_read_b128 v[188:191], v52 offset:3072
    v_accvgpr_read_b32 v128, a176
    v_accvgpr_read_b32 v129, a177
    v_accvgpr_read_b32 v130, a178
    v_accvgpr_read_b32 v131, a179
    v_accvgpr_read_b32 v132, a180
    v_accvgpr_read_b32 v133, a181
    v_accvgpr_read_b32 v134, a182
    v_accvgpr_read_b32 v135, a183
    v_accvgpr_read_b32 v136, a184
    v_accvgpr_read_b32 v137, a185
    v_accvgpr_read_b32 v138, a186
    v_accvgpr_read_b32 v139, a187
    v_accvgpr_read_b32 v140, a188
    v_accvgpr_read_b32 v141, a189
    v_accvgpr_read_b32 v142, a190
    v_accvgpr_read_b32 v143, a191
    s_waitcnt lgkmcnt(0)
    v_pk_add_f32 v[144:145], v[144:145], v[160:161]
    v_pk_add_f32 v[146:147], v[146:147], v[162:163]
    v_pk_add_f32 v[148:149], v[148:149], v[164:165]
    v_pk_add_f32 v[150:151], v[150:151], v[166:167]
    v_pk_add_f32 v[152:153], v[152:153], v[168:169]
    v_pk_add_f32 v[154:155], v[154:155], v[170:171]
    v_pk_add_f32 v[156:157], v[156:157], v[172:173]
    v_pk_add_f32 v[158:159], v[158:159], v[174:175]
    v_pk_add_f32 v[128:129], v[128:129], v[176:177]
    v_pk_add_f32 v[130:131], v[130:131], v[178:179]
    v_pk_add_f32 v[132:133], v[132:133], v[180:181]
    v_pk_add_f32 v[134:135], v[134:135], v[182:183]
    v_pk_add_f32 v[136:137], v[136:137], v[184:185]
    v_pk_add_f32 v[138:139], v[138:139], v[186:187]
    v_pk_add_f32 v[140:141], v[140:141], v[188:189]
    v_pk_add_f32 v[142:143], v[142:143], v[190:191]
    v_pk_add_f32 v[128:129], v[128:129], v[144:145]
    v_pk_add_f32 v[130:131], v[130:131], v[146:147]
    v_pk_add_f32 v[132:133], v[132:133], v[148:149]
    v_pk_add_f32 v[134:135], v[134:135], v[150:151]
    v_pk_add_f32 v[136:137], v[136:137], v[152:153]
    v_pk_add_f32 v[138:139], v[138:139], v[154:155]
    v_pk_add_f32 v[140:141], v[140:141], v[156:157]
    v_pk_add_f32 v[142:143], v[142:143], v[158:159]
    v_cvt_pk_bf16_f32 v32, v128, v129
    v_cvt_pk_bf16_f32 v33, v130, v131
    v_cvt_pk_bf16_f32 v34, v132, v133
    v_cvt_pk_bf16_f32 v35, v134, v135
    v_cvt_pk_bf16_f32 v36, v136, v137
    v_cvt_pk_bf16_f32 v37, v138, v139
    v_cvt_pk_bf16_f32 v38, v140, v141
    v_cvt_pk_bf16_f32 v39, v142, v143
    v_permlane16_swap_b32 v32, v34
    v_permlane16_swap_b32 v33, v35
    v_permlane16_swap_b32 v36, v38
    v_permlane16_swap_b32 v37, v39
    buffer_store_dwordx4 v[32:35], v49, s[28:31], s81 offen offset:0 nt
    buffer_store_dwordx4 v[36:39], v49, s[28:31], s81 offen offset:64 nt
    s_endpgm
L_exit:
    s_endpgm
.section .rodata,"a"
.p2align 6
.amdhsa_kernel concat_heads__gqa_block_cached__gqa_block_cached__near_ridge_kernel
  .amdhsa_next_free_vgpr 512
  .amdhsa_next_free_sgpr 102
  .amdhsa_accum_offset 256
  .amdhsa_group_segment_fixed_size 0
  .amdhsa_kernarg_size 104
  .amdhsa_user_sgpr_count 2
  .amdhsa_user_sgpr_kernarg_segment_ptr 1
  .amdhsa_system_sgpr_workgroup_id_x 1
.end_amdhsa_kernel
```
